```python
import torch

def _softmax(x, axis=-1):
    return torch.softmax(x, dim=axis)
def _gelu(x):
    return torch.nn.functional.gelu(x, approximate="tanh")
def _silu(x):
    return torch.nn.functional.silu(x)
def _sigmoid(x):
    return torch.sigmoid(x)
def _layernorm(x, axis=-1, eps=1e-5):
    m = x.mean(dim=axis, keepdim=True)
    v = x.var(dim=axis, keepdim=True, unbiased=False)
    return (x - m) / torch.sqrt(v + eps)
def _scatter_add(tgt, idx, src, axis=0):
    return tgt.clone().index_add_(axis, idx, src)
def _segment_sum(src, seg, n):
    out = torch.zeros((n,) + src.shape[1:], dtype=src.dtype)
    return out.index_add_(0, seg, src)
def _pad(x, pw):
    flat = tuple(v for pair in reversed(pw) for v in pair)
    return torch.nn.functional.pad(x, flat)

kernel_name = 'sequential_preLN__softmax_full_mha__dense_activation_gelu__prompt'

def setup_inputs():

    _w = (lambda a: (lambda t: t.to(torch.bfloat16) if t.is_floating_point() else t)(torch.as_tensor(a)))
    def _A_setup():
        B, S, D = 1, 2048, 512
        return {
            "x": _w((lambda *s: torch.randn(*s, dtype=torch.bfloat16) * 0.05)(B, S, D)),
            "wqkv": _w((lambda *s: torch.randn(*s, dtype=torch.bfloat16) * 0.05)(D, 3 * D)),
            "wo": _w((lambda *s: torch.randn(*s, dtype=torch.bfloat16) * 0.05)(D, D)),
        }
    _A_in = _A_setup()

    def _B_setup():
        B, S, D, F = 1, 2048, 512, 1792
        return {
            "x": _w((lambda *s: torch.randn(*s, dtype=torch.bfloat16) * 0.05)(B, S, D)),
            "w1": _w((lambda *s: torch.randn(*s, dtype=torch.bfloat16) * 0.8)(D, F) * (D ** -0.5)),
            "b1": _w((lambda *s: torch.randn(*s, dtype=torch.bfloat16) * 0.2)(F) * 0.01),
            "w2": _w((lambda *s: torch.randn(*s, dtype=torch.bfloat16) * 0.2)(F, D) * (F ** -0.5)),
            "b2": _w((lambda *s: torch.randn(*s, dtype=torch.bfloat16) * 0.2)(D) * 0.01),
        }
    _B_in = _B_setup()

    return {
        "A_x": _A_in["x"],
        "A_wqkv": _A_in["wqkv"],
        "A_wo": _A_in["wo"],
        "B_x": _B_in["x"],
        "B_w1": _B_in["w1"],
        "B_b1": _B_in["b1"],
        "B_w2": _B_in["w2"],
        "B_b2": _B_in["b2"],
    }

def reference(A_x, A_wqkv, A_wo, B_x, B_w1, B_b1, B_w2, B_b2):
    def _A_ref(x, wqkv, wo):
        B, S, D = x.shape
        H = 32; Dh = D // H
        qkv = (lambda x, *d: x.permute(*d))((x @ wqkv).reshape(B, S, 3, H, Dh), 2, 0, 3, 1, 4)
        q, k, v = qkv[0], qkv[1], qkv[2]
        scale = Dh ** -0.5
        scores = torch.einsum("bhqd,bhkd->bhqk", q, k) * scale
        p = _softmax(scores, axis=-1)
        o = torch.einsum("bhqk,bhkd->bhqd", p, v)
        return (lambda x, *d: x.permute(*d))(o, 0, 2, 1, 3).reshape(B, S, D) @ wo

    def _B_ref(x, w1, b1, w2, b2):
        h = torch.einsum("bsd,df->bsf", x, w1) + b1
        h = _gelu(h)
        return torch.einsum("bsf,fd->bsd", h, w2) + b2

    x = A_x
    h = x + _A_ref(_layernorm(x, axis=-1), A_wqkv, A_wo)
    h2 = h + _B_ref(_layernorm(h, axis=-1), B_w1, B_b1, B_w2, B_b2)
    return h2
```

```asm
; @launch kernel=qkv_kernel grid=(254,1,1) block=(768,1,1) lds=163840
; @launch kernel=mlp_kernel grid=(256,1,1) block=(512,1,1) lds=152640
.amdgcn_target "amdgcn-amd-amdhsa--gfx950"
.text
.globl qkv_kernel
.p2align 8
.type qkv_kernel,@function
qkv_kernel:
    s_cmp_ge_u32 s2, 254
    s_cbranch_scc1 q_end
    s_load_dwordx4 s[24:27], s[0:1], 0
    s_load_dwordx2 s[28:29], s[0:1], 80
    s_cmp_ge_u32 s2, 206
    s_cbranch_scc1 q_rl
    s_cmp_ge_u32 s2, 192
    s_cbranch_scc1 q_cs
    v_lshrrev_b32 v2, 6, v0
    s_and_b32 s3, s2, 7
    s_lshr_b32 s4, s2, 3
    v_readfirstlane_b32 s6, v2
    s_and_b32 s5, s3, 3
    s_lshl_b32 s5, s5, 2
    s_and_b32 s9, s4, 3
    s_add_u32 s30, s5, s9
    s_lshr_b32 s5, s3, 2
    s_mul_i32 s5, s5, 6
    s_lshr_b32 s9, s4, 2
    s_add_u32 s31, s5, s9
    s_cmp_ge_u32 s6, 4
    s_cbranch_scc0 q_comp
    s_cmp_ge_u32 s6, 8
    s_cbranch_scc1 q_stw
    s_sub_u32 s7, s6, 4
    v_and_b32 v3, 63, v0
    v_lshrrev_b32 v4, 3, v3
    s_lshl_b32 s8, s7, 3
    v_add_u32 v4, s8, v4
    v_lshlrev_b32 v4, 10, v4
    v_lshrrev_b32 v5, 4, v3
    s_and_b32 s8, s7, 1
    s_lshl_b32 s8, s8, 2
    v_add_u32 v6, s8, v5
    v_and_b32 v7, 7, v3
    v_xor_b32 v6, v6, v7
    v_lshl_add_u32 v1, v6, 4, v4
    s_lshl_b32 s8, s7, 2
    v_add_u32 v4, s8, v5
    v_mul_u32_u24 v4, 3072, v4
    v_bfe_u32 v6, v3, 2, 2
    v_xor_b32 v6, v6, v5
    v_and_b32 v7, 3, v3
    v_lshl_add_u32 v6, v6, 2, v7
    v_lshl_add_u32 v2, v6, 4, v4
    s_lshl_b32 s42, s7, 10
    s_mov_b32 s43, 0
    s_lshl_b32 s40, s30, 17
    s_lshl_b32 s41, s31, 8
    s_waitcnt lgkmcnt(0)
    s_mov_b32 s12, s24
    s_mov_b32 s13, s25
    s_mov_b32 s14, 0x200000
    s_mov_b32 s15, 0x00020000
    s_mov_b32 s16, s26
    s_mov_b32 s17, s27
    s_mov_b32 s18, 0x180000
    s_mov_b32 s19, 0x00020000
    s_mov_b32 s47, 3
q_li0:
    s_add_u32 s44, s42, s43
    s_mov_b32 s45, s40
    s_mov_b32 s46, s41
    s_mov_b32 m0, s44
    s_add_u32 s44, s44, 4096
    buffer_load_dwordx4 v1, s[12:15], s45 offen lds
    s_add_u32 m0, s44, 12288
    s_add_u32 s45, s45, 32768
    buffer_load_dwordx4 v2, s[16:19], s46 offen lds
    s_add_u32 s46, s46, 49152
    s_mov_b32 m0, s44
    s_add_u32 s44, s44, 4096
    buffer_load_dwordx4 v1, s[12:15], s45 offen lds
    s_add_u32 m0, s44, 12288
    s_add_u32 s45, s45, 32768
    buffer_load_dwordx4 v2, s[16:19], s46 offen lds
    s_add_u32 s46, s46, 49152
    s_mov_b32 m0, s44
    s_add_u32 s44, s44, 4096
    buffer_load_dwordx4 v1, s[12:15], s45 offen lds
    s_add_u32 m0, s44, 12288
    s_add_u32 s45, s45, 32768
    buffer_load_dwordx4 v2, s[16:19], s46 offen lds
    s_add_u32 s46, s46, 49152
    s_mov_b32 m0, s44
    s_add_u32 s44, s44, 4096
    buffer_load_dwordx4 v1, s[12:15], s45 offen lds
    s_add_u32 m0, s44, 12288
    s_add_u32 s45, s45, 32768
    buffer_load_dwordx4 v2, s[16:19], s46 offen lds
    s_add_u32 s46, s46, 49152
    s_add_u32 s40, s40, 128
    s_add_u32 s41, s41, 196608
    s_add_u32 s43, s43, 32768
    s_cmp_eq_u32 s43, 163840
    s_cselect_b32 s43, 0, s43
    s_sub_u32 s47, s47, 1
    s_cmp_lg_u32 s47, 0
    s_cbranch_scc1 q_li0
    s_mov_b32 s47, 5
q_lb1:
    s_waitcnt vmcnt(16)
    s_barrier
    s_add_u32 s44, s42, s43
    s_mov_b32 s45, s40
    s_mov_b32 s46, s41
    s_mov_b32 m0, s44
    s_add_u32 s44, s44, 4096
    buffer_load_dwordx4 v1, s[12:15], s45 offen lds
    s_add_u32 m0, s44, 12288
    s_add_u32 s45, s45, 32768
    buffer_load_dwordx4 v2, s[16:19], s46 offen lds
    s_add_u32 s46, s46, 49152
    s_mov_b32 m0, s44
    s_add_u32 s44, s44, 4096
    buffer_load_dwordx4 v1, s[12:15], s45 offen lds
    s_add_u32 m0, s44, 12288
    s_add_u32 s45, s45, 32768
    buffer_load_dwordx4 v2, s[16:19], s46 offen lds
    s_add_u32 s46, s46, 49152
    s_mov_b32 m0, s44
    s_add_u32 s44, s44, 4096
    buffer_load_dwordx4 v1, s[12:15], s45 offen lds
    s_add_u32 m0, s44, 12288
    s_add_u32 s45, s45, 32768
    buffer_load_dwordx4 v2, s[16:19], s46 offen lds
    s_add_u32 s46, s46, 49152
    s_mov_b32 m0, s44
    s_add_u32 s44, s44, 4096
    buffer_load_dwordx4 v1, s[12:15], s45 offen lds
    s_add_u32 m0, s44, 12288
    s_add_u32 s45, s45, 32768
    buffer_load_dwordx4 v2, s[16:19], s46 offen lds
    s_add_u32 s46, s46, 49152
    s_add_u32 s40, s40, 128
    s_add_u32 s41, s41, 196608
    s_add_u32 s43, s43, 32768
    s_cmp_eq_u32 s43, 163840
    s_cselect_b32 s43, 0, s43
    s_sub_u32 s47, s47, 1
    s_cmp_lg_u32 s47, 0
    s_cbranch_scc1 q_lb1
    s_waitcnt vmcnt(16)
    s_barrier
    s_waitcnt vmcnt(8)
    s_barrier
    s_waitcnt vmcnt(0)
    s_barrier
    s_waitcnt vmcnt(0)
    s_barrier
    s_endpgm
q_stw:
    s_sub_u32 s7, s6, 8
    v_and_b32 v3, 63, v0
    v_and_b32 v4, 31, v3
    v_lshrrev_b32 v5, 5, v3
    v_bfe_u32 v6, v3, 1, 3
    v_xor_b32 v6, v6, v5
    v_lshlrev_b32 v6, 4, v6
    s_lshl_b32 s9, s7, 5
    v_add_u32 v7, s9, v4
    v_lshlrev_b32 v7, 7, v7
    v_xor_b32 v8, 0, v6
    v_add_u32 v8, v8, v7
    v_xor_b32 v9, 32, v6
    v_add_u32 v9, v9, v7
    v_xor_b32 v10, 64, v6
    v_add_u32 v10, v10, v7
    v_xor_b32 v11, 96, v6
    v_add_u32 v11, v11, v7
    v_mov_b32 v21, 0xffff0000
    v_mov_b32 v22, 0
    v_mov_b32 v23, 0
    v_mov_b32 v24, 0
    v_mov_b32 v25, 0
    s_mov_b32 s20, 0
    s_mov_b32 s21, 0
q_st:
    s_barrier
    ds_read_b128 v[32:35], v8
    ds_read_b128 v[36:39], v9
    ds_read_b128 v[40:43], v10
    ds_read_b128 v[44:47], v11
    s_add_u32 s22, s21, 32768
    s_cmp_eq_u32 s22, 163840
    s_cselect_b32 s22, 0, s22
    s_sub_u32 s23, s22, s21
    s_mov_b32 s21, s22
    v_add_u32 v8, s23, v8
    v_add_u32 v9, s23, v9
    v_add_u32 v10, s23, v10
    v_add_u32 v11, s23, v11
    s_waitcnt lgkmcnt(3)
    v_lshlrev_b32 v26, 16, v32
    v_and_b32 v27, v21, v32
    v_add_f32 v22, v22, v26
    v_add_f32 v23, v23, v27
    v_fmac_f32 v24, v26, v26
    v_fmac_f32 v25, v27, v27
    v_lshlrev_b32 v28, 16, v33
    v_and_b32 v29, v21, v33
    v_add_f32 v22, v22, v28
    v_add_f32 v23, v23, v29
    v_fmac_f32 v24, v28, v28
    v_fmac_f32 v25, v29, v29
    v_lshlrev_b32 v26, 16, v34
    v_and_b32 v27, v21, v34
    v_add_f32 v22, v22, v26
    v_add_f32 v23, v23, v27
    v_fmac_f32 v24, v26, v26
    v_fmac_f32 v25, v27, v27
    v_lshlrev_b32 v28, 16, v35
    v_and_b32 v29, v21, v35
    v_add_f32 v22, v22, v28
    v_add_f32 v23, v23, v29
    v_fmac_f32 v24, v28, v28
    v_fmac_f32 v25, v29, v29
    s_waitcnt lgkmcnt(2)
    v_lshlrev_b32 v26, 16, v36
    v_and_b32 v27, v21, v36
    v_add_f32 v22, v22, v26
    v_add_f32 v23, v23, v27
    v_fmac_f32 v24, v26, v26
    v_fmac_f32 v25, v27, v27
    v_lshlrev_b32 v28, 16, v37
    v_and_b32 v29, v21, v37
    v_add_f32 v22, v22, v28
    v_add_f32 v23, v23, v29
    v_fmac_f32 v24, v28, v28
    v_fmac_f32 v25, v29, v29
    v_lshlrev_b32 v26, 16, v38
    v_and_b32 v27, v21, v38
    v_add_f32 v22, v22, v26
    v_add_f32 v23, v23, v27
    v_fmac_f32 v24, v26, v26
    v_fmac_f32 v25, v27, v27
    v_lshlrev_b32 v28, 16, v39
    v_and_b32 v29, v21, v39
    v_add_f32 v22, v22, v28
    v_add_f32 v23, v23, v29
    v_fmac_f32 v24, v28, v28
    v_fmac_f32 v25, v29, v29
    s_waitcnt lgkmcnt(1)
    v_lshlrev_b32 v26, 16, v40
    v_and_b32 v27, v21, v40
    v_add_f32 v22, v22, v26
    v_add_f32 v23, v23, v27
    v_fmac_f32 v24, v26, v26
    v_fmac_f32 v25, v27, v27
    v_lshlrev_b32 v28, 16, v41
    v_and_b32 v29, v21, v41
    v_add_f32 v22, v22, v28
    v_add_f32 v23, v23, v29
    v_fmac_f32 v24, v28, v28
    v_fmac_f32 v25, v29, v29
    v_lshlrev_b32 v26, 16, v42
    v_and_b32 v27, v21, v42
    v_add_f32 v22, v22, v26
    v_add_f32 v23, v23, v27
    v_fmac_f32 v24, v26, v26
    v_fmac_f32 v25, v27, v27
    v_lshlrev_b32 v28, 16, v43
    v_and_b32 v29, v21, v43
    v_add_f32 v22, v22, v28
    v_add_f32 v23, v23, v29
    v_fmac_f32 v24, v28, v28
    v_fmac_f32 v25, v29, v29
    s_waitcnt lgkmcnt(0)
    v_lshlrev_b32 v26, 16, v44
    v_and_b32 v27, v21, v44
    v_add_f32 v22, v22, v26
    v_add_f32 v23, v23, v27
    v_fmac_f32 v24, v26, v26
    v_fmac_f32 v25, v27, v27
    v_lshlrev_b32 v28, 16, v45
    v_and_b32 v29, v21, v45
    v_add_f32 v22, v22, v28
    v_add_f32 v23, v23, v29
    v_fmac_f32 v24, v28, v28
    v_fmac_f32 v25, v29, v29
    v_lshlrev_b32 v26, 16, v46
    v_and_b32 v27, v21, v46
    v_add_f32 v22, v22, v26
    v_add_f32 v23, v23, v27
    v_fmac_f32 v24, v26, v26
    v_fmac_f32 v25, v27, v27
    v_lshlrev_b32 v28, 16, v47
    v_and_b32 v29, v21, v47
    v_add_f32 v22, v22, v28
    v_add_f32 v23, v23, v29
    v_fmac_f32 v24, v28, v28
    v_fmac_f32 v25, v29, v29
    s_add_u32 s20, s20, 1
    s_cmp_lt_u32 s20, 8
    s_cbranch_scc1 q_st
    s_barrier
    v_add_f32 v22, v22, v23
    v_add_f32 v24, v24, v25
    v_mov_b32 v23, v22
    v_mov_b32 v25, v24
    s_nop 1
    v_permlane32_swap_b32 v22, v23
    v_permlane32_swap_b32 v24, v25
    s_nop 1
    v_add_f32 v22, v22, v23
    v_add_f32 v24, v24, v25
    v_mul_f32 v22, 0x3b000000, v22
    v_mul_f32 v24, 0x3b000000, v24
    v_fma_f32 v24, -v22, v22, v24
    v_max_f32 v24, 0, v24
    v_add_f32 v24, 0x3727c5ac, v24
    v_rsq_f32 v24, v24
    s_mov_b32 s36, 0x3eb8aa3b
    s_cmp_lt_u32 s31, 4
    s_cselect_b32 s36, s36, 1.0
    v_mul_f32 v24, s36, v24
    v_mul_f32 v22, v22, v24
    v_sub_f32 v22, 0, v22
    v_add_u32 v28, s9, v4
    v_lshlrev_b32 v28, 2, v28
    s_barrier
    ds_write_b32 v28, v24
    ds_write_b32 v28, v22 offset:512
    s_waitcnt lgkmcnt(0)
    s_barrier
    s_endpgm
q_rl:
    v_and_b32 v3, 63, v0
    v_lshrrev_b32 v2, 6, v0
    s_sub_u32 s3, s2, 206
    s_and_b32 s4, s2, 7
    v_readfirstlane_b32 s6, v2
    s_lshr_b32 s5, s3, 3
    s_mul_i32 s5, s5, 12
    s_add_u32 s5, s5, s6
    s_waitcnt lgkmcnt(0)
    s_mov_b32 s12, s24
    s_mov_b32 s13, s25
    s_mov_b32 s14, 0x200000
    s_mov_b32 s15, 0x00020000
    s_mov_b32 s16, s26
    s_mov_b32 s17, s27
    s_mov_b32 s18, 0x180000
    s_mov_b32 s19, 0x00020000
    v_lshrrev_b32 v4, 3, v3
    v_lshlrev_b32 v4, 10, v4
    v_and_b32 v5, 7, v3
    v_lshl_add_u32 v4, v5, 4, v4
    s_and_b32 s7, s4, 3
    s_lshl_b32 s7, s7, 19
    s_lshl_b32 s8, s5, 13
    s_add_u32 s7, s7, s8
    s_add_u32 s7, s7, 384
    v_lshlrev_b32 v6, 4, v3
    s_lshr_b32 s9, s4, 2
    s_mul_i32 s9, s9, 1536
    s_add_u32 s10, s5, 192
    s_mul_i32 s10, s10, 3072
    s_add_u32 s10, s10, s9
    s_cmp_lt_u32 s5, 64
    s_cbranch_scc0 q_pfw
    buffer_load_dwordx4 v[8:11], v4, s[12:15], s7 offen offset:0
    buffer_load_dwordx4 v[8:11], v4, s[12:15], s7 offen offset:128
    buffer_load_dwordx4 v[8:11], v4, s[12:15], s7 offen offset:256
    buffer_load_dwordx4 v[8:11], v4, s[12:15], s7 offen offset:384
    buffer_load_dwordx4 v[8:11], v4, s[12:15], s7 offen offset:512
q_pfw:
    s_cmp_lt_u32 s5, 64
    s_cbranch_scc1 q_nocp
    s_getpc_b64 s[48:49]
q_pcref:
    s_add_u32 s48, s48, mlp_kernel-q_pcref
    s_addc_u32 s49, s49, 0
    s_sub_u32 s52, s5, 64
    s_lshl_b32 s52, s52, 10
    v_add_u32 v7, s52, v6
    global_load_dwordx4 v[8:11], v7, s[48:49]
q_nocp:
    buffer_load_dwordx4 v[8:11], v6, s[16:19], s10 offen
    buffer_load_dwordx4 v[8:11], v6, s[16:19], s10 offen offset:1024
    s_add_u32 s10, s10, 221184
    buffer_load_dwordx4 v[8:11], v6, s[16:19], s10 offen
    buffer_load_dwordx4 v[8:11], v6, s[16:19], s10 offen offset:1024
    s_add_u32 s10, s10, 221184
    buffer_load_dwordx4 v[8:11], v6, s[16:19], s10 offen
    buffer_load_dwordx4 v[8:11], v6, s[16:19], s10 offen offset:1024
    s_add_u32 s10, s10, 221184
    buffer_load_dwordx4 v[8:11], v6, s[16:19], s10 offen
    buffer_load_dwordx4 v[8:11], v6, s[16:19], s10 offen offset:1024
    s_add_u32 s10, s10, 221184
    buffer_load_dwordx4 v[8:11], v6, s[16:19], s10 offen
    buffer_load_dwordx4 v[8:11], v6, s[16:19], s10 offen offset:1024
    s_add_u32 s10, s10, 221184
    s_endpgm
q_cs:
    v_cmp_gt_u32 vcc, 512, v0
    s_and_saveexec_b64 s[8:9], vcc
    s_cbranch_execz q_csdone
    s_load_dwordx2 s[44:45], s[0:1], 32
    s_sub_u32 s3, s2, 192
    v_and_b32 v1, 15, v0
    v_lshrrev_b32 v2, 4, v0
    v_mul_u32_u24 v3, 3584, v2
    v_lshl_add_u32 v3, v1, 4, v3
    s_lshl_b32 s4, s3, 8
    s_waitcnt lgkmcnt(0)
    s_mov_b32 s12, s44
    s_mov_b32 s13, s45
    s_mov_b32 s14, 0x1c0000
    s_mov_b32 s15, 0x00020000
    s_mov_b32 s32, s28
    s_mov_b32 s33, s29
    s_mov_b32 s34, 0x10000000
    s_mov_b32 s35, 0x00020000
    s_cmp_lg_u32 s3, 0
    s_cbranch_scc1 q_nz
    v_lshlrev_b32 v4, 4, v0
    v_mov_b32 v8, 0
    v_mov_b32 v9, 0
    v_mov_b32 v10, 0
    v_mov_b32 v11, 0
    s_mov_b32 s5, 0x1290000
    buffer_store_dwordx4 v[8:11], v4, s[32:35], s5 offen
    s_add_u32 s5, s5, 8192
    buffer_store_dwordx4 v[8:11], v4, s[32:35], s5 offen
    s_nop 1
q_nz:
    buffer_load_dwordx4 v[16:19], v3, s[12:15], s4 offen
    s_add_u32 s4, s4, 114688
    buffer_load_dwordx4 v[20:23], v3, s[12:15], s4 offen
    s_add_u32 s4, s4, 114688
    buffer_load_dwordx4 v[24:27], v3, s[12:15], s4 offen
    s_add_u32 s4, s4, 114688
    buffer_load_dwordx4 v[28:31], v3, s[12:15], s4 offen
    s_add_u32 s4, s4, 114688
    buffer_load_dwordx4 v[32:35], v3, s[12:15], s4 offen
    s_add_u32 s4, s4, 114688
    buffer_load_dwordx4 v[36:39], v3, s[12:15], s4 offen
    s_add_u32 s4, s4, 114688
    buffer_load_dwordx4 v[40:43], v3, s[12:15], s4 offen
    s_add_u32 s4, s4, 114688
    buffer_load_dwordx4 v[44:47], v3, s[12:15], s4 offen
    s_add_u32 s4, s4, 114688
    buffer_load_dwordx4 v[48:51], v3, s[12:15], s4 offen
    s_add_u32 s4, s4, 114688
    buffer_load_dwordx4 v[52:55], v3, s[12:15], s4 offen
    s_add_u32 s4, s4, 114688
    buffer_load_dwordx4 v[56:59], v3, s[12:15], s4 offen
    s_add_u32 s4, s4, 114688
    buffer_load_dwordx4 v[60:63], v3, s[12:15], s4 offen
    s_add_u32 s4, s4, 114688
    buffer_load_dwordx4 v[64:67], v3, s[12:15], s4 offen
    s_add_u32 s4, s4, 114688
    buffer_load_dwordx4 v[68:71], v3, s[12:15], s4 offen
    s_add_u32 s4, s4, 114688
    buffer_load_dwordx4 v[72:75], v3, s[12:15], s4 offen
    s_add_u32 s4, s4, 114688
    buffer_load_dwordx4 v[76:79], v3, s[12:15], s4 offen
    s_add_u32 s4, s4, 114688
    v_mov_b32 v8, 0
    v_mov_b32 v9, 0
    v_mov_b32 v10, 0
    v_mov_b32 v11, 0
    v_mov_b32 v12, 0
    v_mov_b32 v13, 0
    v_mov_b32 v14, 0
    v_mov_b32 v15, 0
    s_waitcnt vmcnt(15)
    v_lshlrev_b32 v4, 16, v16
    v_and_b32 v5, 0xffff0000, v16
    v_add_f32 v8, v8, v4
    v_add_f32 v9, v9, v5
    v_lshlrev_b32 v4, 16, v17
    v_and_b32 v5, 0xffff0000, v17
    v_add_f32 v10, v10, v4
    v_add_f32 v11, v11, v5
    v_lshlrev_b32 v4, 16, v18
    v_and_b32 v5, 0xffff0000, v18
    v_add_f32 v12, v12, v4
    v_add_f32 v13, v13, v5
    v_lshlrev_b32 v4, 16, v19
    v_and_b32 v5, 0xffff0000, v19
    v_add_f32 v14, v14, v4
    v_add_f32 v15, v15, v5
    s_waitcnt vmcnt(14)
    v_lshlrev_b32 v4, 16, v20
    v_and_b32 v5, 0xffff0000, v20
    v_add_f32 v8, v8, v4
    v_add_f32 v9, v9, v5
    v_lshlrev_b32 v4, 16, v21
    v_and_b32 v5, 0xffff0000, v21
    v_add_f32 v10, v10, v4
    v_add_f32 v11, v11, v5
    v_lshlrev_b32 v4, 16, v22
    v_and_b32 v5, 0xffff0000, v22
    v_add_f32 v12, v12, v4
    v_add_f32 v13, v13, v5
    v_lshlrev_b32 v4, 16, v23
    v_and_b32 v5, 0xffff0000, v23
    v_add_f32 v14, v14, v4
    v_add_f32 v15, v15, v5
    s_waitcnt vmcnt(13)
    v_lshlrev_b32 v4, 16, v24
    v_and_b32 v5, 0xffff0000, v24
    v_add_f32 v8, v8, v4
    v_add_f32 v9, v9, v5
    v_lshlrev_b32 v4, 16, v25
    v_and_b32 v5, 0xffff0000, v25
    v_add_f32 v10, v10, v4
    v_add_f32 v11, v11, v5
    v_lshlrev_b32 v4, 16, v26
    v_and_b32 v5, 0xffff0000, v26
    v_add_f32 v12, v12, v4
    v_add_f32 v13, v13, v5
    v_lshlrev_b32 v4, 16, v27
    v_and_b32 v5, 0xffff0000, v27
    v_add_f32 v14, v14, v4
    v_add_f32 v15, v15, v5
    s_waitcnt vmcnt(12)
    v_lshlrev_b32 v4, 16, v28
    v_and_b32 v5, 0xffff0000, v28
    v_add_f32 v8, v8, v4
    v_add_f32 v9, v9, v5
    v_lshlrev_b32 v4, 16, v29
    v_and_b32 v5, 0xffff0000, v29
    v_add_f32 v10, v10, v4
    v_add_f32 v11, v11, v5
    v_lshlrev_b32 v4, 16, v30
    v_and_b32 v5, 0xffff0000, v30
    v_add_f32 v12, v12, v4
    v_add_f32 v13, v13, v5
    v_lshlrev_b32 v4, 16, v31
    v_and_b32 v5, 0xffff0000, v31
    v_add_f32 v14, v14, v4
    v_add_f32 v15, v15, v5
    s_waitcnt vmcnt(11)
    v_lshlrev_b32 v4, 16, v32
    v_and_b32 v5, 0xffff0000, v32
    v_add_f32 v8, v8, v4
    v_add_f32 v9, v9, v5
    v_lshlrev_b32 v4, 16, v33
    v_and_b32 v5, 0xffff0000, v33
    v_add_f32 v10, v10, v4
    v_add_f32 v11, v11, v5
    v_lshlrev_b32 v4, 16, v34
    v_and_b32 v5, 0xffff0000, v34
    v_add_f32 v12, v12, v4
    v_add_f32 v13, v13, v5
    v_lshlrev_b32 v4, 16, v35
    v_and_b32 v5, 0xffff0000, v35
    v_add_f32 v14, v14, v4
    v_add_f32 v15, v15, v5
    s_waitcnt vmcnt(10)
    v_lshlrev_b32 v4, 16, v36
    v_and_b32 v5, 0xffff0000, v36
    v_add_f32 v8, v8, v4
    v_add_f32 v9, v9, v5
    v_lshlrev_b32 v4, 16, v37
    v_and_b32 v5, 0xffff0000, v37
    v_add_f32 v10, v10, v4
    v_add_f32 v11, v11, v5
    v_lshlrev_b32 v4, 16, v38
    v_and_b32 v5, 0xffff0000, v38
    v_add_f32 v12, v12, v4
    v_add_f32 v13, v13, v5
    v_lshlrev_b32 v4, 16, v39
    v_and_b32 v5, 0xffff0000, v39
    v_add_f32 v14, v14, v4
    v_add_f32 v15, v15, v5
    s_waitcnt vmcnt(9)
    v_lshlrev_b32 v4, 16, v40
    v_and_b32 v5, 0xffff0000, v40
    v_add_f32 v8, v8, v4
    v_add_f32 v9, v9, v5
    v_lshlrev_b32 v4, 16, v41
    v_and_b32 v5, 0xffff0000, v41
    v_add_f32 v10, v10, v4
    v_add_f32 v11, v11, v5
    v_lshlrev_b32 v4, 16, v42
    v_and_b32 v5, 0xffff0000, v42
    v_add_f32 v12, v12, v4
    v_add_f32 v13, v13, v5
    v_lshlrev_b32 v4, 16, v43
    v_and_b32 v5, 0xffff0000, v43
    v_add_f32 v14, v14, v4
    v_add_f32 v15, v15, v5
    s_waitcnt vmcnt(8)
    v_lshlrev_b32 v4, 16, v44
    v_and_b32 v5, 0xffff0000, v44
    v_add_f32 v8, v8, v4
    v_add_f32 v9, v9, v5
    v_lshlrev_b32 v4, 16, v45
    v_and_b32 v5, 0xffff0000, v45
    v_add_f32 v10, v10, v4
    v_add_f32 v11, v11, v5
    v_lshlrev_b32 v4, 16, v46
    v_and_b32 v5, 0xffff0000, v46
    v_add_f32 v12, v12, v4
    v_add_f32 v13, v13, v5
    v_lshlrev_b32 v4, 16, v47
    v_and_b32 v5, 0xffff0000, v47
    v_add_f32 v14, v14, v4
    v_add_f32 v15, v15, v5
    s_waitcnt vmcnt(7)
    v_lshlrev_b32 v4, 16, v48
    v_and_b32 v5, 0xffff0000, v48
    v_add_f32 v8, v8, v4
    v_add_f32 v9, v9, v5
    v_lshlrev_b32 v4, 16, v49
    v_and_b32 v5, 0xffff0000, v49
    v_add_f32 v10, v10, v4
    v_add_f32 v11, v11, v5
    v_lshlrev_b32 v4, 16, v50
    v_and_b32 v5, 0xffff0000, v50
    v_add_f32 v12, v12, v4
    v_add_f32 v13, v13, v5
    v_lshlrev_b32 v4, 16, v51
    v_and_b32 v5, 0xffff0000, v51
    v_add_f32 v14, v14, v4
    v_add_f32 v15, v15, v5
    s_waitcnt vmcnt(6)
    v_lshlrev_b32 v4, 16, v52
    v_and_b32 v5, 0xffff0000, v52
    v_add_f32 v8, v8, v4
    v_add_f32 v9, v9, v5
    v_lshlrev_b32 v4, 16, v53
    v_and_b32 v5, 0xffff0000, v53
    v_add_f32 v10, v10, v4
    v_add_f32 v11, v11, v5
    v_lshlrev_b32 v4, 16, v54
    v_and_b32 v5, 0xffff0000, v54
    v_add_f32 v12, v12, v4
    v_add_f32 v13, v13, v5
    v_lshlrev_b32 v4, 16, v55
    v_and_b32 v5, 0xffff0000, v55
    v_add_f32 v14, v14, v4
    v_add_f32 v15, v15, v5
    s_waitcnt vmcnt(5)
    v_lshlrev_b32 v4, 16, v56
    v_and_b32 v5, 0xffff0000, v56
    v_add_f32 v8, v8, v4
    v_add_f32 v9, v9, v5
    v_lshlrev_b32 v4, 16, v57
    v_and_b32 v5, 0xffff0000, v57
    v_add_f32 v10, v10, v4
    v_add_f32 v11, v11, v5
    v_lshlrev_b32 v4, 16, v58
    v_and_b32 v5, 0xffff0000, v58
    v_add_f32 v12, v12, v4
    v_add_f32 v13, v13, v5
    v_lshlrev_b32 v4, 16, v59
    v_and_b32 v5, 0xffff0000, v59
    v_add_f32 v14, v14, v4
    v_add_f32 v15, v15, v5
    s_waitcnt vmcnt(4)
    v_lshlrev_b32 v4, 16, v60
    v_and_b32 v5, 0xffff0000, v60
    v_add_f32 v8, v8, v4
    v_add_f32 v9, v9, v5
    v_lshlrev_b32 v4, 16, v61
    v_and_b32 v5, 0xffff0000, v61
    v_add_f32 v10, v10, v4
    v_add_f32 v11, v11, v5
    v_lshlrev_b32 v4, 16, v62
    v_and_b32 v5, 0xffff0000, v62
    v_add_f32 v12, v12, v4
    v_add_f32 v13, v13, v5
    v_lshlrev_b32 v4, 16, v63
    v_and_b32 v5, 0xffff0000, v63
    v_add_f32 v14, v14, v4
    v_add_f32 v15, v15, v5
    s_waitcnt vmcnt(3)
    v_lshlrev_b32 v4, 16, v64
    v_and_b32 v5, 0xffff0000, v64
    v_add_f32 v8, v8, v4
    v_add_f32 v9, v9, v5
    v_lshlrev_b32 v4, 16, v65
    v_and_b32 v5, 0xffff0000, v65
    v_add_f32 v10, v10, v4
    v_add_f32 v11, v11, v5
    v_lshlrev_b32 v4, 16, v66
    v_and_b32 v5, 0xffff0000, v66
    v_add_f32 v12, v12, v4
    v_add_f32 v13, v13, v5
    v_lshlrev_b32 v4, 16, v67
    v_and_b32 v5, 0xffff0000, v67
    v_add_f32 v14, v14, v4
    v_add_f32 v15, v15, v5
    s_waitcnt vmcnt(2)
    v_lshlrev_b32 v4, 16, v68
    v_and_b32 v5, 0xffff0000, v68
    v_add_f32 v8, v8, v4
    v_add_f32 v9, v9, v5
    v_lshlrev_b32 v4, 16, v69
    v_and_b32 v5, 0xffff0000, v69
    v_add_f32 v10, v10, v4
    v_add_f32 v11, v11, v5
    v_lshlrev_b32 v4, 16, v70
    v_and_b32 v5, 0xffff0000, v70
    v_add_f32 v12, v12, v4
    v_add_f32 v13, v13, v5
    v_lshlrev_b32 v4, 16, v71
    v_and_b32 v5, 0xffff0000, v71
    v_add_f32 v14, v14, v4
    v_add_f32 v15, v15, v5
    s_waitcnt vmcnt(1)
    v_lshlrev_b32 v4, 16, v72
    v_and_b32 v5, 0xffff0000, v72
    v_add_f32 v8, v8, v4
    v_add_f32 v9, v9, v5
    v_lshlrev_b32 v4, 16, v73
    v_and_b32 v5, 0xffff0000, v73
    v_add_f32 v10, v10, v4
    v_add_f32 v11, v11, v5
    v_lshlrev_b32 v4, 16, v74
    v_and_b32 v5, 0xffff0000, v74
    v_add_f32 v12, v12, v4
    v_add_f32 v13, v13, v5
    v_lshlrev_b32 v4, 16, v75
    v_and_b32 v5, 0xffff0000, v75
    v_add_f32 v14, v14, v4
    v_add_f32 v15, v15, v5
    s_waitcnt vmcnt(0)
    v_lshlrev_b32 v4, 16, v76
    v_and_b32 v5, 0xffff0000, v76
    v_add_f32 v8, v8, v4
    v_add_f32 v9, v9, v5
    v_lshlrev_b32 v4, 16, v77
    v_and_b32 v5, 0xffff0000, v77
    v_add_f32 v10, v10, v4
    v_add_f32 v11, v11, v5
    v_lshlrev_b32 v4, 16, v78
    v_and_b32 v5, 0xffff0000, v78
    v_add_f32 v12, v12, v4
    v_add_f32 v13, v13, v5
    v_lshlrev_b32 v4, 16, v79
    v_and_b32 v5, 0xffff0000, v79
    v_add_f32 v14, v14, v4
    v_add_f32 v15, v15, v5
    v_lshlrev_b32 v4, 9, v2
    v_lshl_add_u32 v4, v1, 5, v4
    ds_write_b128 v4, v[8:11]
    ds_write_b128 v4, v[12:15] offset:16
    s_waitcnt lgkmcnt(0)
    s_barrier
    v_cmp_gt_u32 vcc, 128, v0
    s_and_saveexec_b64 s[8:9], vcc
    s_cbranch_execz q_csdone
    v_lshlrev_b32 v4, 2, v0
    ds_read_b32 v16, v4 offset:0
    ds_read_b32 v17, v4 offset:512
    ds_read_b32 v18, v4 offset:1024
    ds_read_b32 v19, v4 offset:1536
    ds_read_b32 v20, v4 offset:2048
    ds_read_b32 v21, v4 offset:2560
    ds_read_b32 v22, v4 offset:3072
    ds_read_b32 v23, v4 offset:3584
    ds_read_b32 v24, v4 offset:4096
    ds_read_b32 v25, v4 offset:4608
    ds_read_b32 v26, v4 offset:5120
    ds_read_b32 v27, v4 offset:5632
    ds_read_b32 v28, v4 offset:6144
    ds_read_b32 v29, v4 offset:6656
    ds_read_b32 v30, v4 offset:7168
    s_waitcnt lgkmcnt(0)
    ds_read_b32 v31, v4 offset:7680
    ds_read_b32 v32, v4 offset:8192
    ds_read_b32 v33, v4 offset:8704
    ds_read_b32 v34, v4 offset:9216
    ds_read_b32 v35, v4 offset:9728
    ds_read_b32 v36, v4 offset:10240
    ds_read_b32 v37, v4 offset:10752
    ds_read_b32 v38, v4 offset:11264
    ds_read_b32 v39, v4 offset:11776
    ds_read_b32 v40, v4 offset:12288
    ds_read_b32 v41, v4 offset:12800
    ds_read_b32 v42, v4 offset:13312
    ds_read_b32 v43, v4 offset:13824
    ds_read_b32 v44, v4 offset:14336
    ds_read_b32 v45, v4 offset:14848
    s_waitcnt lgkmcnt(0)
    ds_read_b32 v46, v4 offset:15360
    ds_read_b32 v47, v4 offset:15872
    s_waitcnt lgkmcnt(0)
    v_add_f32 v16, v16, v17
    v_add_f32 v16, v16, v18
    v_add_f32 v16, v16, v19
    v_add_f32 v16, v16, v20
    v_add_f32 v16, v16, v21
    v_add_f32 v16, v16, v22
    v_add_f32 v16, v16, v23
    v_add_f32 v16, v16, v24
    v_add_f32 v16, v16, v25
    v_add_f32 v16, v16, v26
    v_add_f32 v16, v16, v27
    v_add_f32 v16, v16, v28
    v_add_f32 v16, v16, v29
    v_add_f32 v16, v16, v30
    v_add_f32 v16, v16, v31
    v_add_f32 v16, v16, v32
    v_add_f32 v16, v16, v33
    v_add_f32 v16, v16, v34
    v_add_f32 v16, v16, v35
    v_add_f32 v16, v16, v36
    v_add_f32 v16, v16, v37
    v_add_f32 v16, v16, v38
    v_add_f32 v16, v16, v39
    v_add_f32 v16, v16, v40
    v_add_f32 v16, v16, v41
    v_add_f32 v16, v16, v42
    v_add_f32 v16, v16, v43
    v_add_f32 v16, v16, v44
    v_add_f32 v16, v16, v45
    v_add_f32 v16, v16, v46
    v_add_f32 v16, v16, v47
    s_lshl_b32 s4, s3, 9
    s_add_u32 s4, s4, 0x1280000
    buffer_store_dword v16, v4, s[32:35], s4 offen
q_csdone:
    s_endpgm
q_comp:
    s_lshr_b32 s7, s6, 1
    s_and_b32 s8, s6, 1
    v_and_b32 v3, 63, v0
    v_and_b32 v4, 31, v3
    v_lshrrev_b32 v5, 5, v3
    v_bfe_u32 v6, v3, 1, 3
    v_xor_b32 v6, v6, v5
    v_lshlrev_b32 v6, 4, v6
    s_lshl_b32 s9, s7, 6
    s_lshl_b32 s10, s8, 5
    s_add_u32 s9, s9, s10
    v_add_u32 v7, s9, v4
    v_lshlrev_b32 v7, 7, v7
    v_xor_b32 v8, 0, v6
    v_add_u32 v8, v8, v7
    v_xor_b32 v12, 4096, v8
    v_xor_b32 v9, 32, v6
    v_add_u32 v9, v9, v7
    v_xor_b32 v13, 4096, v9
    v_xor_b32 v10, 64, v6
    v_add_u32 v10, v10, v7
    v_xor_b32 v14, 4096, v10
    v_xor_b32 v11, 96, v6
    v_add_u32 v11, v11, v7
    v_xor_b32 v15, 4096, v11
    v_lshrrev_b32 v6, 4, v3
    v_bfe_u32 v7, v3, 2, 2
    v_and_b32 v18, 3, v3
    v_and_b32 v19, 1, v6
    v_lshl_add_u32 v18, v19, 2, v18
    v_and_b32 v19, 1, v18
    v_lshlrev_b32 v19, 1, v19
    v_bfe_u32 v20, v18, 1, 1
    v_and_b32 v18, 4, v18
    v_or3_b32 v18, v18, v19, v20
    v_lshrrev_b32 v6, 1, v6
    v_lshl_add_u32 v6, v6, 3, v7
    v_lshlrev_b32 v6, 8, v6
    s_lshl_b32 s9, s8, 1
    s_add_u32 s9, s9, s7
    v_xor_b32 v7, s9, v7
    v_lshlrev_b32 v7, 6, v7
    v_add3_u32 v16, v6, v7, 0
    v_lshl_add_u32 v16, v18, 3, v16
    v_add_u32 v16, 16384, v16
    v_xor_b32 v17, 64, v16
    v_mov_b32 v96, 0
    v_mov_b32 v97, 0
    v_mov_b32 v98, 0
    v_mov_b32 v99, 0
    v_mov_b32 v100, 0
    v_mov_b32 v101, 0
    v_mov_b32 v102, 0
    v_mov_b32 v103, 0
    v_mov_b32 v104, 0
    v_mov_b32 v105, 0
    v_mov_b32 v106, 0
    v_mov_b32 v107, 0
    v_mov_b32 v108, 0
    v_mov_b32 v109, 0
    v_mov_b32 v110, 0
    v_mov_b32 v111, 0
    v_mov_b32 v112, 0
    v_mov_b32 v113, 0
    v_mov_b32 v114, 0
    v_mov_b32 v115, 0
    v_mov_b32 v116, 0
    v_mov_b32 v117, 0
    v_mov_b32 v118, 0
    v_mov_b32 v119, 0
    v_mov_b32 v120, 0
    v_mov_b32 v121, 0
    v_mov_b32 v122, 0
    v_mov_b32 v123, 0
    v_mov_b32 v124, 0
    v_mov_b32 v125, 0
    v_mov_b32 v126, 0
    v_mov_b32 v127, 0
    v_mov_b32 v128, 0
    v_mov_b32 v129, 0
    v_mov_b32 v130, 0
    v_mov_b32 v131, 0
    v_mov_b32 v132, 0
    v_mov_b32 v133, 0
    v_mov_b32 v134, 0
    v_mov_b32 v135, 0
    v_mov_b32 v136, 0
    v_mov_b32 v137, 0
    v_mov_b32 v138, 0
    v_mov_b32 v139, 0
    v_mov_b32 v140, 0
    v_mov_b32 v141, 0
    v_mov_b32 v142, 0
    v_mov_b32 v143, 0
    v_mov_b32 v144, 0
    v_mov_b32 v145, 0
    v_mov_b32 v146, 0
    v_mov_b32 v147, 0
    v_mov_b32 v148, 0
    v_mov_b32 v149, 0
    v_mov_b32 v150, 0
    v_mov_b32 v151, 0
    v_mov_b32 v152, 0
    v_mov_b32 v153, 0
    v_mov_b32 v154, 0
    v_mov_b32 v155, 0
    v_mov_b32 v156, 0
    v_mov_b32 v157, 0
    v_mov_b32 v158, 0
    v_mov_b32 v159, 0
    v_mov_b32 v24, 0
    v_mov_b32 v25, 0
    v_mov_b32 v26, 0
    v_mov_b32 v27, 0
    v_and_b32 v28, 15, v3
    v_bfe_u32 v29, v3, 4, 1
    v_cmp_eq_u32 vcc, v28, v29
    v_mov_b32 v30, 0x3f803f80
    s_nop 0
    v_cndmask_b32 v20, 0, v30, vcc
    v_mov_b32 v21, v20
    v_mov_b32 v22, v20
    v_mov_b32 v23, v20
    s_xor_b32 s9, s7, 0
    s_lshl_b32 s9, s9, 5
    s_lshl_b32 s10, s8, 6
    s_add_u32 s50, s9, s10
    s_xor_b32 s9, s7, 1
    s_lshl_b32 s9, s9, 5
    s_lshl_b32 s10, s8, 6
    s_add_u32 s51, s9, s10
    s_xor_b32 s9, s8, 0
    s_lshl_b32 s9, s9, 5
    s_lshl_b32 s10, s7, 6
    s_add_u32 s52, s9, s10
    s_xor_b32 s9, s8, 1
    s_lshl_b32 s9, s9, 5
    s_lshl_b32 s10, s7, 6
    s_add_u32 s53, s9, s10
    s_waitcnt lgkmcnt(0)
    s_mov_b32 s32, s28
    s_mov_b32 s33, s29
    s_mov_b32 s34, 0x10000000
    s_mov_b32 s35, 0x00020000
    s_cmp_ge_u32 s31, 8
    s_cbranch_scc1 q_vpath
    s_barrier
    ds_read_b128 v[32:35], v8
    ds_read_b64_tr_b16 v[40:41], v16 offset:0
    ds_read_b64_tr_b16 v[42:43], v16 offset:1024
    ds_read_b128 v[36:39], v12
    ds_read_b64_tr_b16 v[44:45], v17 offset:0
    ds_read_b64_tr_b16 v[46:47], v17 offset:1024
    ds_read_b128 v[48:51], v9
    ds_read_b64_tr_b16 v[56:57], v16 offset:4096
    ds_read_b64_tr_b16 v[58:59], v16 offset:5120
    ds_read_b128 v[52:55], v13
    ds_read_b64_tr_b16 v[60:61], v17 offset:4096
    ds_read_b64_tr_b16 v[62:63], v17 offset:5120
    s_mov_b32 s20, 0
    s_mov_b32 s21, 0
q_akloop:
    s_add_u32 s22, s21, 32768
    s_cmp_eq_u32 s22, 163840
    s_cselect_b32 s22, 0, s22
    s_sub_u32 s23, s22, s21
    s_mov_b32 s21, s22
    s_waitcnt lgkmcnt(6)
    v_mfma_f32_32x32x16_bf16 v[96:111], v[40:43], v[32:35], v[96:111]
    ds_read_b128 v[64:67], v10
    ds_read_b64_tr_b16 v[72:73], v16 offset:8192
    v_mfma_f32_32x32x16_bf16 v[112:127], v[40:43], v[36:39], v[112:127]
    ds_read_b64_tr_b16 v[74:75], v16 offset:9216
    ds_read_b128 v[68:71], v14
    v_mfma_f32_32x32x16_bf16 v[128:143], v[44:47], v[32:35], v[128:143]
    ds_read_b64_tr_b16 v[76:77], v17 offset:8192
    ds_read_b64_tr_b16 v[78:79], v17 offset:9216
    v_mfma_f32_32x32x16_bf16 v[144:159], v[44:47], v[36:39], v[144:159]
    v_add_u32 v10, s23, v10
    v_add_u32 v14, s23, v14
    v_mfma_f32_16x16x32_bf16 v[24:27], v[20:23], v[40:43], v[24:27]
    s_waitcnt lgkmcnt(6)
    v_mfma_f32_32x32x16_bf16 v[96:111], v[56:59], v[48:51], v[96:111]
    ds_read_b128 v[80:83], v11
    ds_read_b64_tr_b16 v[88:89], v16 offset:12288
    v_mfma_f32_32x32x16_bf16 v[112:127], v[56:59], v[52:55], v[112:127]
    ds_read_b64_tr_b16 v[90:91], v16 offset:13312
    ds_read_b128 v[84:87], v15
    v_mfma_f32_32x32x16_bf16 v[128:143], v[60:63], v[48:51], v[128:143]
    ds_read_b64_tr_b16 v[92:93], v17 offset:12288
    ds_read_b64_tr_b16 v[94:95], v17 offset:13312
    v_mfma_f32_32x32x16_bf16 v[144:159], v[60:63], v[52:55], v[144:159]
    v_add_u32 v11, s23, v11
    v_add_u32 v15, s23, v15
    v_add_u32 v8, s23, v8
    v_add_u32 v12, s23, v12
    v_add_u32 v9, s23, v9
    v_add_u32 v13, s23, v13
    v_add_u32 v16, s23, v16
    v_add_u32 v17, s23, v17
    v_mfma_f32_16x16x32_bf16 v[24:27], v[20:23], v[56:59], v[24:27]
    s_waitcnt lgkmcnt(6)
    s_barrier
    v_mfma_f32_32x32x16_bf16 v[96:111], v[72:75], v[64:67], v[96:111]
    ds_read_b128 v[32:35], v8
    ds_read_b64_tr_b16 v[40:41], v16 offset:0
    v_mfma_f32_32x32x16_bf16 v[112:127], v[72:75], v[68:71], v[112:127]
    ds_read_b64_tr_b16 v[42:43], v16 offset:1024
    ds_read_b128 v[36:39], v12
    v_mfma_f32_32x32x16_bf16 v[128:143], v[76:79], v[64:67], v[128:143]
    ds_read_b64_tr_b16 v[44:45], v17 offset:0
    ds_read_b64_tr_b16 v[46:47], v17 offset:1024
    v_mfma_f32_32x32x16_bf16 v[144:159], v[76:79], v[68:71], v[144:159]
    v_mfma_f32_16x16x32_bf16 v[24:27], v[20:23], v[72:75], v[24:27]
    s_waitcnt lgkmcnt(6)
    v_mfma_f32_32x32x16_bf16 v[96:111], v[88:91], v[80:83], v[96:111]
    ds_read_b128 v[48:51], v9
    ds_read_b64_tr_b16 v[56:57], v16 offset:4096
    v_mfma_f32_32x32x16_bf16 v[112:127], v[88:91], v[84:87], v[112:127]
    ds_read_b64_tr_b16 v[58:59], v16 offset:5120
    ds_read_b128 v[52:55], v13
    v_mfma_f32_32x32x16_bf16 v[128:143], v[92:95], v[80:83], v[128:143]
    ds_read_b64_tr_b16 v[60:61], v17 offset:4096
    ds_read_b64_tr_b16 v[62:63], v17 offset:5120
    v_mfma_f32_32x32x16_bf16 v[144:159], v[92:95], v[84:87], v[144:159]
    v_mfma_f32_16x16x32_bf16 v[24:27], v[20:23], v[88:91], v[24:27]
    s_add_u32 s20, s20, 1
    s_cmp_lt_u32 s20, 8
    s_cbranch_scc1 q_akloop
    s_waitcnt lgkmcnt(0)
    s_barrier
    v_lshrrev_b32 v29, 2, v4
    v_and_b32 v30, 1, v29
    v_lshlrev_b32 v30, 1, v30
    v_bfe_u32 v31, v29, 1, 1
    v_and_b32 v29, 4, v29
    v_or3_b32 v29, v29, v30, v31
    v_and_b32 v30, 3, v4
    v_lshl_add_u32 v29, v29, 2, v30
    v_add_u32 v30, s50, v29
    v_lshlrev_b32 v30, 2, v30
    v_lshl_add_u32 v30, v5, 12, v30
    v_permlane16_swap_b32 v24, v25
    s_nop 1
    ds_write_b32 v30, v24 offset:1024
    s_waitcnt lgkmcnt(0)
    s_barrier
    v_add_u32 v28, s52, v4
    v_lshlrev_b32 v28, 2, v28
    ds_read2st64_b32 v[8:9], v28 offset0:0 offset1:2
    v_add_u32 v28, s53, v4
    v_lshlrev_b32 v28, 2, v28
    ds_read2st64_b32 v[10:11], v28 offset0:0 offset1:2
    v_lshl_add_u32 v28, v5, 3, s50
    v_lshlrev_b32 v28, 2, v28
    ds_read_b128 v[32:35], v28 offset:1024
    ds_read_b128 v[36:39], v28 offset:1040
    ds_read_b128 v[40:43], v28 offset:1088
    ds_read_b128 v[44:47], v28 offset:1104
    v_lshl_add_u32 v28, v5, 3, s51
    v_lshlrev_b32 v28, 2, v28
    ds_read_b128 v[48:51], v28 offset:1024
    ds_read_b128 v[52:55], v28 offset:1040
    ds_read_b128 v[56:59], v28 offset:1088
    ds_read_b128 v[60:63], v28 offset:1104
    s_and_b32 s9, s31, 3
    s_lshl_b32 s9, s9, 19
    s_cmp_lt_u32 s31, 4
    s_cselect_b32 s10, 0x0, 0x200000
    s_add_u32 s37, s9, s10
    s_lshl_b32 s9, s30, 12
    s_add_u32 s37, s37, s9
    v_lshlrev_b32 v1, 4, v3
    s_waitcnt lgkmcnt(0)
    v_pk_mul_f32 v[64:65], v[32:33], v[8:9] op_sel:[0,1] op_sel_hi:[1,1]
    v_pk_mul_f32 v[66:67], v[34:35], v[8:9] op_sel:[0,1] op_sel_hi:[1,1]
    v_pk_mul_f32 v[68:69], v[36:37], v[8:9] op_sel:[0,1] op_sel_hi:[1,1]
    v_pk_mul_f32 v[70:71], v[38:39], v[8:9] op_sel:[0,1] op_sel_hi:[1,1]
    v_pk_mul_f32 v[72:73], v[40:41], v[8:9] op_sel:[0,1] op_sel_hi:[1,1]
    v_pk_mul_f32 v[74:75], v[42:43], v[8:9] op_sel:[0,1] op_sel_hi:[1,1]
    v_pk_mul_f32 v[76:77], v[44:45], v[8:9] op_sel:[0,1] op_sel_hi:[1,1]
    v_pk_mul_f32 v[78:79], v[46:47], v[8:9] op_sel:[0,1] op_sel_hi:[1,1]
    v_pk_fma_f32 v[96:97], v[96:97], v[8:9], v[64:65] op_sel_hi:[1,0,1]
    v_pk_fma_f32 v[98:99], v[98:99], v[8:9], v[66:67] op_sel_hi:[1,0,1]
    v_pk_fma_f32 v[100:101], v[100:101], v[8:9], v[68:69] op_sel_hi:[1,0,1]
    v_pk_fma_f32 v[102:103], v[102:103], v[8:9], v[70:71] op_sel_hi:[1,0,1]
    v_pk_fma_f32 v[104:105], v[104:105], v[8:9], v[72:73] op_sel_hi:[1,0,1]
    v_pk_fma_f32 v[106:107], v[106:107], v[8:9], v[74:75] op_sel_hi:[1,0,1]
    v_pk_fma_f32 v[108:109], v[108:109], v[8:9], v[76:77] op_sel_hi:[1,0,1]
    v_pk_fma_f32 v[110:111], v[110:111], v[8:9], v[78:79] op_sel_hi:[1,0,1]
    v_cvt_pk_bf16_f32 v96, v96, v97
    v_cvt_pk_bf16_f32 v97, v98, v99
    v_cvt_pk_bf16_f32 v98, v100, v101
    v_cvt_pk_bf16_f32 v99, v102, v103
    v_cvt_pk_bf16_f32 v100, v104, v105
    v_cvt_pk_bf16_f32 v101, v106, v107
    v_cvt_pk_bf16_f32 v102, v108, v109
    v_cvt_pk_bf16_f32 v103, v110, v111
    s_lshl_b32 s9, s50, 12
    s_lshl_b32 s10, s52, 5
    s_add_u32 s9, s9, s10
    s_add_u32 s9, s9, s37
    s_add_u32 s10, s9, 65536
    buffer_store_dwordx4 v[96:99], v1, s[32:35], s9 offen
    buffer_store_dwordx4 v[100:103], v1, s[32:35], s10 offen
    v_pk_mul_f32 v[64:65], v[32:33], v[10:11] op_sel:[0,1] op_sel_hi:[1,1]
    v_pk_mul_f32 v[66:67], v[34:35], v[10:11] op_sel:[0,1] op_sel_hi:[1,1]
    v_pk_mul_f32 v[68:69], v[36:37], v[10:11] op_sel:[0,1] op_sel_hi:[1,1]
    v_pk_mul_f32 v[70:71], v[38:39], v[10:11] op_sel:[0,1] op_sel_hi:[1,1]
    v_pk_mul_f32 v[72:73], v[40:41], v[10:11] op_sel:[0,1] op_sel_hi:[1,1]
    v_pk_mul_f32 v[74:75], v[42:43], v[10:11] op_sel:[0,1] op_sel_hi:[1,1]
    v_pk_mul_f32 v[76:77], v[44:45], v[10:11] op_sel:[0,1] op_sel_hi:[1,1]
    v_pk_mul_f32 v[78:79], v[46:47], v[10:11] op_sel:[0,1] op_sel_hi:[1,1]
    v_pk_fma_f32 v[112:113], v[112:113], v[10:11], v[64:65] op_sel_hi:[1,0,1]
    v_pk_fma_f32 v[114:115], v[114:115], v[10:11], v[66:67] op_sel_hi:[1,0,1]
    v_pk_fma_f32 v[116:117], v[116:117], v[10:11], v[68:69] op_sel_hi:[1,0,1]
    v_pk_fma_f32 v[118:119], v[118:119], v[10:11], v[70:71] op_sel_hi:[1,0,1]
    v_pk_fma_f32 v[120:121], v[120:121], v[10:11], v[72:73] op_sel_hi:[1,0,1]
    v_pk_fma_f32 v[122:123], v[122:123], v[10:11], v[74:75] op_sel_hi:[1,0,1]
    v_pk_fma_f32 v[124:125], v[124:125], v[10:11], v[76:77] op_sel_hi:[1,0,1]
    v_pk_fma_f32 v[126:127], v[126:127], v[10:11], v[78:79] op_sel_hi:[1,0,1]
    v_cvt_pk_bf16_f32 v112, v112, v113
    v_cvt_pk_bf16_f32 v113, v114, v115
    v_cvt_pk_bf16_f32 v114, v116, v117
    v_cvt_pk_bf16_f32 v115, v118, v119
    v_cvt_pk_bf16_f32 v116, v120, v121
    v_cvt_pk_bf16_f32 v117, v122, v123
    v_cvt_pk_bf16_f32 v118, v124, v125
    v_cvt_pk_bf16_f32 v119, v126, v127
    s_lshl_b32 s9, s50, 12
    s_lshl_b32 s10, s53, 5
    s_add_u32 s9, s9, s10
    s_add_u32 s9, s9, s37
    s_add_u32 s10, s9, 65536
    buffer_store_dwordx4 v[112:115], v1, s[32:35], s9 offen
    buffer_store_dwordx4 v[116:119], v1, s[32:35], s10 offen
    v_pk_mul_f32 v[64:65], v[48:49], v[8:9] op_sel:[0,1] op_sel_hi:[1,1]
    v_pk_mul_f32 v[66:67], v[50:51], v[8:9] op_sel:[0,1] op_sel_hi:[1,1]
    v_pk_mul_f32 v[68:69], v[52:53], v[8:9] op_sel:[0,1] op_sel_hi:[1,1]
    v_pk_mul_f32 v[70:71], v[54:55], v[8:9] op_sel:[0,1] op_sel_hi:[1,1]
    v_pk_mul_f32 v[72:73], v[56:57], v[8:9] op_sel:[0,1] op_sel_hi:[1,1]
    v_pk_mul_f32 v[74:75], v[58:59], v[8:9] op_sel:[0,1] op_sel_hi:[1,1]
    v_pk_mul_f32 v[76:77], v[60:61], v[8:9] op_sel:[0,1] op_sel_hi:[1,1]
    v_pk_mul_f32 v[78:79], v[62:63], v[8:9] op_sel:[0,1] op_sel_hi:[1,1]
    v_pk_fma_f32 v[128:129], v[128:129], v[8:9], v[64:65] op_sel_hi:[1,0,1]
    v_pk_fma_f32 v[130:131], v[130:131], v[8:9], v[66:67] op_sel_hi:[1,0,1]
    v_pk_fma_f32 v[132:133], v[132:133], v[8:9], v[68:69] op_sel_hi:[1,0,1]
    v_pk_fma_f32 v[134:135], v[134:135], v[8:9], v[70:71] op_sel_hi:[1,0,1]
    v_pk_fma_f32 v[136:137], v[136:137], v[8:9], v[72:73] op_sel_hi:[1,0,1]
    v_pk_fma_f32 v[138:139], v[138:139], v[8:9], v[74:75] op_sel_hi:[1,0,1]
    v_pk_fma_f32 v[140:141], v[140:141], v[8:9], v[76:77] op_sel_hi:[1,0,1]
    v_pk_fma_f32 v[142:143], v[142:143], v[8:9], v[78:79] op_sel_hi:[1,0,1]
    v_cvt_pk_bf16_f32 v128, v128, v129
    v_cvt_pk_bf16_f32 v129, v130, v131
    v_cvt_pk_bf16_f32 v130, v132, v133
    v_cvt_pk_bf16_f32 v131, v134, v135
    v_cvt_pk_bf16_f32 v132, v136, v137
    v_cvt_pk_bf16_f32 v133, v138, v139
    v_cvt_pk_bf16_f32 v134, v140, v141
    v_cvt_pk_bf16_f32 v135, v142, v143
    s_lshl_b32 s9, s51, 12
    s_lshl_b32 s10, s52, 5
    s_add_u32 s9, s9, s10
    s_add_u32 s9, s9, s37
    s_add_u32 s10, s9, 65536
    buffer_store_dwordx4 v[128:131], v1, s[32:35], s9 offen
    buffer_store_dwordx4 v[132:135], v1, s[32:35], s10 offen
    v_pk_mul_f32 v[64:65], v[48:49], v[10:11] op_sel:[0,1] op_sel_hi:[1,1]
    v_pk_mul_f32 v[66:67], v[50:51], v[10:11] op_sel:[0,1] op_sel_hi:[1,1]
    v_pk_mul_f32 v[68:69], v[52:53], v[10:11] op_sel:[0,1] op_sel_hi:[1,1]
    v_pk_mul_f32 v[70:71], v[54:55], v[10:11] op_sel:[0,1] op_sel_hi:[1,1]
    v_pk_mul_f32 v[72:73], v[56:57], v[10:11] op_sel:[0,1] op_sel_hi:[1,1]
    v_pk_mul_f32 v[74:75], v[58:59], v[10:11] op_sel:[0,1] op_sel_hi:[1,1]
    v_pk_mul_f32 v[76:77], v[60:61], v[10:11] op_sel:[0,1] op_sel_hi:[1,1]
    v_pk_mul_f32 v[78:79], v[62:63], v[10:11] op_sel:[0,1] op_sel_hi:[1,1]
    v_pk_fma_f32 v[144:145], v[144:145], v[10:11], v[64:65] op_sel_hi:[1,0,1]
    v_pk_fma_f32 v[146:147], v[146:147], v[10:11], v[66:67] op_sel_hi:[1,0,1]
    v_pk_fma_f32 v[148:149], v[148:149], v[10:11], v[68:69] op_sel_hi:[1,0,1]
    v_pk_fma_f32 v[150:151], v[150:151], v[10:11], v[70:71] op_sel_hi:[1,0,1]
    v_pk_fma_f32 v[152:153], v[152:153], v[10:11], v[72:73] op_sel_hi:[1,0,1]
    v_pk_fma_f32 v[154:155], v[154:155], v[10:11], v[74:75] op_sel_hi:[1,0,1]
    v_pk_fma_f32 v[156:157], v[156:157], v[10:11], v[76:77] op_sel_hi:[1,0,1]
    v_pk_fma_f32 v[158:159], v[158:159], v[10:11], v[78:79] op_sel_hi:[1,0,1]
    v_cvt_pk_bf16_f32 v144, v144, v145
    v_cvt_pk_bf16_f32 v145, v146, v147
    v_cvt_pk_bf16_f32 v146, v148, v149
    v_cvt_pk_bf16_f32 v147, v150, v151
    v_cvt_pk_bf16_f32 v148, v152, v153
    v_cvt_pk_bf16_f32 v149, v154, v155
    v_cvt_pk_bf16_f32 v150, v156, v157
    v_cvt_pk_bf16_f32 v151, v158, v159
    s_lshl_b32 s9, s51, 12
    s_lshl_b32 s10, s53, 5
    s_add_u32 s9, s9, s10
    s_add_u32 s9, s9, s37
    s_add_u32 s10, s9, 65536
    buffer_store_dwordx4 v[144:147], v1, s[32:35], s9 offen
    buffer_store_dwordx4 v[148:151], v1, s[32:35], s10 offen
    s_endpgm
q_vpath:
    s_barrier
    ds_read_b128 v[32:35], v8
    ds_read_b64_tr_b16 v[40:41], v16 offset:0
    ds_read_b64_tr_b16 v[42:43], v16 offset:1024
    ds_read_b128 v[36:39], v12
    ds_read_b64_tr_b16 v[44:45], v17 offset:0
    ds_read_b64_tr_b16 v[46:47], v17 offset:1024
    ds_read_b128 v[48:51], v9
    ds_read_b64_tr_b16 v[56:57], v16 offset:4096
    ds_read_b64_tr_b16 v[58:59], v16 offset:5120
    ds_read_b128 v[52:55], v13
    ds_read_b64_tr_b16 v[60:61], v17 offset:4096
    ds_read_b64_tr_b16 v[62:63], v17 offset:5120
    s_mov_b32 s20, 0
    s_mov_b32 s21, 0
q_bkloop:
    s_add_u32 s22, s21, 32768
    s_cmp_eq_u32 s22, 163840
    s_cselect_b32 s22, 0, s22
    s_sub_u32 s23, s22, s21
    s_mov_b32 s21, s22
    s_waitcnt lgkmcnt(6)
    v_mfma_f32_32x32x16_bf16 v[96:111], v[32:35], v[40:43], v[96:111]
    ds_read_b128 v[64:67], v10
    ds_read_b64_tr_b16 v[72:73], v16 offset:8192
    v_mfma_f32_32x32x16_bf16 v[112:127], v[36:39], v[40:43], v[112:127]
    ds_read_b64_tr_b16 v[74:75], v16 offset:9216
    ds_read_b128 v[68:71], v14
    v_mfma_f32_32x32x16_bf16 v[128:143], v[32:35], v[44:47], v[128:143]
    ds_read_b64_tr_b16 v[76:77], v17 offset:8192
    ds_read_b64_tr_b16 v[78:79], v17 offset:9216
    v_mfma_f32_32x32x16_bf16 v[144:159], v[36:39], v[44:47], v[144:159]
    v_add_u32 v10, s23, v10
    v_add_u32 v14, s23, v14
    v_mfma_f32_16x16x32_bf16 v[24:27], v[20:23], v[40:43], v[24:27]
    s_waitcnt lgkmcnt(6)
    v_mfma_f32_32x32x16_bf16 v[96:111], v[48:51], v[56:59], v[96:111]
    ds_read_b128 v[80:83], v11
    ds_read_b64_tr_b16 v[88:89], v16 offset:12288
    v_mfma_f32_32x32x16_bf16 v[112:127], v[52:55], v[56:59], v[112:127]
    ds_read_b64_tr_b16 v[90:91], v16 offset:13312
    ds_read_b128 v[84:87], v15
    v_mfma_f32_32x32x16_bf16 v[128:143], v[48:51], v[60:63], v[128:143]
    ds_read_b64_tr_b16 v[92:93], v17 offset:12288
    ds_read_b64_tr_b16 v[94:95], v17 offset:13312
    v_mfma_f32_32x32x16_bf16 v[144:159], v[52:55], v[60:63], v[144:159]
    v_add_u32 v11, s23, v11
    v_add_u32 v15, s23, v15
    v_add_u32 v8, s23, v8
    v_add_u32 v12, s23, v12
    v_add_u32 v9, s23, v9
    v_add_u32 v13, s23, v13
    v_add_u32 v16, s23, v16
    v_add_u32 v17, s23, v17
    v_mfma_f32_16x16x32_bf16 v[24:27], v[20:23], v[56:59], v[24:27]
    s_waitcnt lgkmcnt(6)
    s_barrier
    v_mfma_f32_32x32x16_bf16 v[96:111], v[64:67], v[72:75], v[96:111]
    ds_read_b128 v[32:35], v8
    ds_read_b64_tr_b16 v[40:41], v16 offset:0
    v_mfma_f32_32x32x16_bf16 v[112:127], v[68:71], v[72:75], v[112:127]
    ds_read_b64_tr_b16 v[42:43], v16 offset:1024
    ds_read_b128 v[36:39], v12
    v_mfma_f32_32x32x16_bf16 v[128:143], v[64:67], v[76:79], v[128:143]
    ds_read_b64_tr_b16 v[44:45], v17 offset:0
    ds_read_b64_tr_b16 v[46:47], v17 offset:1024
    v_mfma_f32_32x32x16_bf16 v[144:159], v[68:71], v[76:79], v[144:159]
    v_mfma_f32_16x16x32_bf16 v[24:27], v[20:23], v[72:75], v[24:27]
    s_waitcnt lgkmcnt(6)
    v_mfma_f32_32x32x16_bf16 v[96:111], v[80:83], v[88:91], v[96:111]
    ds_read_b128 v[48:51], v9
    ds_read_b64_tr_b16 v[56:57], v16 offset:4096
    v_mfma_f32_32x32x16_bf16 v[112:127], v[84:87], v[88:91], v[112:127]
    ds_read_b64_tr_b16 v[58:59], v16 offset:5120
    ds_read_b128 v[52:55], v13
    v_mfma_f32_32x32x16_bf16 v[128:143], v[80:83], v[92:95], v[128:143]
    ds_read_b64_tr_b16 v[60:61], v17 offset:4096
    ds_read_b64_tr_b16 v[62:63], v17 offset:5120
    v_mfma_f32_32x32x16_bf16 v[144:159], v[84:87], v[92:95], v[144:159]
    v_mfma_f32_16x16x32_bf16 v[24:27], v[20:23], v[88:91], v[24:27]
    s_add_u32 s20, s20, 1
    s_cmp_lt_u32 s20, 8
    s_cbranch_scc1 q_bkloop
    s_waitcnt lgkmcnt(0)
    s_barrier
    v_lshrrev_b32 v29, 2, v4
    v_and_b32 v30, 1, v29
    v_lshlrev_b32 v30, 1, v30
    v_bfe_u32 v31, v29, 1, 1
    v_and_b32 v29, 4, v29
    v_or3_b32 v29, v29, v30, v31
    v_and_b32 v30, 3, v4
    v_lshl_add_u32 v29, v29, 2, v30
    v_add_u32 v30, s50, v29
    v_lshlrev_b32 v30, 2, v30
    v_lshl_add_u32 v30, v5, 12, v30
    v_permlane16_swap_b32 v24, v25
    s_nop 1
    ds_write_b32 v30, v24 offset:1024
    s_waitcnt lgkmcnt(0)
    s_barrier
    v_add_u32 v28, s50, v29
    v_lshlrev_b32 v28, 2, v28
    ds_read_b32 v8, v28 offset:1024
    v_add_u32 v28, s51, v29
    v_lshlrev_b32 v28, 2, v28
    ds_read_b32 v10, v28 offset:1024
    v_lshl_add_u32 v28, v5, 2, s52
    v_lshlrev_b32 v28, 2, v28
    ds_read_b128 v[32:35], v28 offset:0
    ds_read_b128 v[48:51], v28 offset:512
    ds_read_b128 v[36:39], v28 offset:32
    ds_read_b128 v[52:55], v28 offset:544
    ds_read_b128 v[40:43], v28 offset:64
    ds_read_b128 v[56:59], v28 offset:576
    ds_read_b128 v[44:47], v28 offset:96
    ds_read_b128 v[60:63], v28 offset:608
    s_waitcnt lgkmcnt(0)
    v_lshl_add_u32 v28, v5, 2, s53
    v_lshlrev_b32 v28, 2, v28
    ds_read_b128 v[64:67], v28 offset:0
    ds_read_b128 v[80:83], v28 offset:512
    ds_read_b128 v[68:71], v28 offset:32
    ds_read_b128 v[84:87], v28 offset:544
    ds_read_b128 v[72:75], v28 offset:64
    ds_read_b128 v[88:91], v28 offset:576
    ds_read_b128 v[76:79], v28 offset:96
    ds_read_b128 v[92:95], v28 offset:608
    s_waitcnt lgkmcnt(0)
    v_lshrrev_b32 v1, 4, v4
    v_lshlrev_b32 v1, 16, v1
    v_lshl_add_u32 v1, v5, 9, v1
    v_and_b32 v2, 15, v4
    v_lshl_add_u32 v1, v2, 4, v1
    s_and_b32 s9, s31, 3
    s_lshl_b32 s9, s9, 19
    s_add_u32 s37, s9, 0x400000
    s_lshl_b32 s9, s30, 12
    s_add_u32 s37, s37, s9
    v_pk_mul_f32 v[12:13], v[48:49], v[8:9] op_sel_hi:[1,0]
    v_pk_mul_f32 v[14:15], v[50:51], v[8:9] op_sel_hi:[1,0]
    v_pk_mul_f32 v[16:17], v[52:53], v[8:9] op_sel_hi:[1,0]
    v_pk_mul_f32 v[18:19], v[54:55], v[8:9] op_sel_hi:[1,0]
    v_pk_mul_f32 v[20:21], v[56:57], v[8:9] op_sel_hi:[1,0]
    v_pk_mul_f32 v[22:23], v[58:59], v[8:9] op_sel_hi:[1,0]
    v_pk_mul_f32 v[24:25], v[60:61], v[8:9] op_sel_hi:[1,0]
    v_pk_mul_f32 v[26:27], v[62:63], v[8:9] op_sel_hi:[1,0]
    v_pk_fma_f32 v[96:97], v[96:97], v[32:33], v[12:13]
    v_pk_fma_f32 v[98:99], v[98:99], v[34:35], v[14:15]
    v_pk_fma_f32 v[100:101], v[100:101], v[36:37], v[16:17]
    v_pk_fma_f32 v[102:103], v[102:103], v[38:39], v[18:19]
    v_pk_fma_f32 v[104:105], v[104:105], v[40:41], v[20:21]
    v_pk_fma_f32 v[106:107], v[106:107], v[42:43], v[22:23]
    v_pk_fma_f32 v[108:109], v[108:109], v[44:45], v[24:25]
    v_pk_fma_f32 v[110:111], v[110:111], v[46:47], v[26:27]
    v_cvt_pk_bf16_f32 v96, v96, v97
    v_cvt_pk_bf16_f32 v97, v98, v99
    v_cvt_pk_bf16_f32 v98, v100, v101
    v_cvt_pk_bf16_f32 v99, v102, v103
    v_cvt_pk_bf16_f32 v100, v104, v105
    v_cvt_pk_bf16_f32 v101, v106, v107
    v_cvt_pk_bf16_f32 v102, v108, v109
    v_cvt_pk_bf16_f32 v103, v110, v111
    s_lshl_b32 s9, s50, 12
    s_lshl_b32 s10, s52, 5
    s_add_u32 s9, s9, s10
    s_add_u32 s9, s9, s37
    buffer_store_dwordx4 v[96:99], v1, s[32:35], s9 offen
    buffer_store_dwordx4 v[100:103], v1, s[32:35], s9 offen offset:256
    v_pk_mul_f32 v[12:13], v[80:81], v[8:9] op_sel_hi:[1,0]
    v_pk_mul_f32 v[14:15], v[82:83], v[8:9] op_sel_hi:[1,0]
    v_pk_mul_f32 v[16:17], v[84:85], v[8:9] op_sel_hi:[1,0]
    v_pk_mul_f32 v[18:19], v[86:87], v[8:9] op_sel_hi:[1,0]
    v_pk_mul_f32 v[20:21], v[88:89], v[8:9] op_sel_hi:[1,0]
    v_pk_mul_f32 v[22:23], v[90:91], v[8:9] op_sel_hi:[1,0]
    v_pk_mul_f32 v[24:25], v[92:93], v[8:9] op_sel_hi:[1,0]
    v_pk_mul_f32 v[26:27], v[94:95], v[8:9] op_sel_hi:[1,0]
    v_pk_fma_f32 v[112:113], v[112:113], v[64:65], v[12:13]
    v_pk_fma_f32 v[114:115], v[114:115], v[66:67], v[14:15]
    v_pk_fma_f32 v[116:117], v[116:117], v[68:69], v[16:17]
    v_pk_fma_f32 v[118:119], v[118:119], v[70:71], v[18:19]
    v_pk_fma_f32 v[120:121], v[120:121], v[72:73], v[20:21]
    v_pk_fma_f32 v[122:123], v[122:123], v[74:75], v[22:23]
    v_pk_fma_f32 v[124:125], v[124:125], v[76:77], v[24:25]
    v_pk_fma_f32 v[126:127], v[126:127], v[78:79], v[26:27]
    v_cvt_pk_bf16_f32 v112, v112, v113
    v_cvt_pk_bf16_f32 v113, v114, v115
    v_cvt_pk_bf16_f32 v114, v116, v117
    v_cvt_pk_bf16_f32 v115, v118, v119
    v_cvt_pk_bf16_f32 v116, v120, v121
    v_cvt_pk_bf16_f32 v117, v122, v123
    v_cvt_pk_bf16_f32 v118, v124, v125
    v_cvt_pk_bf16_f32 v119, v126, v127
    s_lshl_b32 s9, s50, 12
    s_lshl_b32 s10, s53, 5
    s_add_u32 s9, s9, s10
    s_add_u32 s9, s9, s37
    buffer_store_dwordx4 v[112:115], v1, s[32:35], s9 offen
    buffer_store_dwordx4 v[116:119], v1, s[32:35], s9 offen offset:256
    v_pk_mul_f32 v[12:13], v[48:49], v[10:11] op_sel_hi:[1,0]
    v_pk_mul_f32 v[14:15], v[50:51], v[10:11] op_sel_hi:[1,0]
    v_pk_mul_f32 v[16:17], v[52:53], v[10:11] op_sel_hi:[1,0]
    v_pk_mul_f32 v[18:19], v[54:55], v[10:11] op_sel_hi:[1,0]
    v_pk_mul_f32 v[20:21], v[56:57], v[10:11] op_sel_hi:[1,0]
    v_pk_mul_f32 v[22:23], v[58:59], v[10:11] op_sel_hi:[1,0]
    v_pk_mul_f32 v[24:25], v[60:61], v[10:11] op_sel_hi:[1,0]
    v_pk_mul_f32 v[26:27], v[62:63], v[10:11] op_sel_hi:[1,0]
    v_pk_fma_f32 v[128:129], v[128:129], v[32:33], v[12:13]
    v_pk_fma_f32 v[130:131], v[130:131], v[34:35], v[14:15]
    v_pk_fma_f32 v[132:133], v[132:133], v[36:37], v[16:17]
    v_pk_fma_f32 v[134:135], v[134:135], v[38:39], v[18:19]
    v_pk_fma_f32 v[136:137], v[136:137], v[40:41], v[20:21]
    v_pk_fma_f32 v[138:139], v[138:139], v[42:43], v[22:23]
    v_pk_fma_f32 v[140:141], v[140:141], v[44:45], v[24:25]
    v_pk_fma_f32 v[142:143], v[142:143], v[46:47], v[26:27]
    v_cvt_pk_bf16_f32 v128, v128, v129
    v_cvt_pk_bf16_f32 v129, v130, v131
    v_cvt_pk_bf16_f32 v130, v132, v133
    v_cvt_pk_bf16_f32 v131, v134, v135
    v_cvt_pk_bf16_f32 v132, v136, v137
    v_cvt_pk_bf16_f32 v133, v138, v139
    v_cvt_pk_bf16_f32 v134, v140, v141
    v_cvt_pk_bf16_f32 v135, v142, v143
    s_lshl_b32 s9, s51, 12
    s_lshl_b32 s10, s52, 5
    s_add_u32 s9, s9, s10
    s_add_u32 s9, s9, s37
    buffer_store_dwordx4 v[128:131], v1, s[32:35], s9 offen
    buffer_store_dwordx4 v[132:135], v1, s[32:35], s9 offen offset:256
    v_pk_mul_f32 v[12:13], v[80:81], v[10:11] op_sel_hi:[1,0]
    v_pk_mul_f32 v[14:15], v[82:83], v[10:11] op_sel_hi:[1,0]
    v_pk_mul_f32 v[16:17], v[84:85], v[10:11] op_sel_hi:[1,0]
    v_pk_mul_f32 v[18:19], v[86:87], v[10:11] op_sel_hi:[1,0]
    v_pk_mul_f32 v[20:21], v[88:89], v[10:11] op_sel_hi:[1,0]
    v_pk_mul_f32 v[22:23], v[90:91], v[10:11] op_sel_hi:[1,0]
    v_pk_mul_f32 v[24:25], v[92:93], v[10:11] op_sel_hi:[1,0]
    v_pk_mul_f32 v[26:27], v[94:95], v[10:11] op_sel_hi:[1,0]
    v_pk_fma_f32 v[144:145], v[144:145], v[64:65], v[12:13]
    v_pk_fma_f32 v[146:147], v[146:147], v[66:67], v[14:15]
    v_pk_fma_f32 v[148:149], v[148:149], v[68:69], v[16:17]
    v_pk_fma_f32 v[150:151], v[150:151], v[70:71], v[18:19]
    v_pk_fma_f32 v[152:153], v[152:153], v[72:73], v[20:21]
    v_pk_fma_f32 v[154:155], v[154:155], v[74:75], v[22:23]
    v_pk_fma_f32 v[156:157], v[156:157], v[76:77], v[24:25]
    v_pk_fma_f32 v[158:159], v[158:159], v[78:79], v[26:27]
    v_cvt_pk_bf16_f32 v144, v144, v145
    v_cvt_pk_bf16_f32 v145, v146, v147
    v_cvt_pk_bf16_f32 v146, v148, v149
    v_cvt_pk_bf16_f32 v147, v150, v151
    v_cvt_pk_bf16_f32 v148, v152, v153
    v_cvt_pk_bf16_f32 v149, v154, v155
    v_cvt_pk_bf16_f32 v150, v156, v157
    v_cvt_pk_bf16_f32 v151, v158, v159
    s_lshl_b32 s9, s51, 12
    s_lshl_b32 s10, s53, 5
    s_add_u32 s9, s9, s10
    s_add_u32 s9, s9, s37
    buffer_store_dwordx4 v[144:147], v1, s[32:35], s9 offen
    buffer_store_dwordx4 v[148:151], v1, s[32:35], s9 offen offset:256
    s_endpgm
q_end:
    s_endpgm
.section .rodata,"a"
.p2align 6
.amdhsa_kernel qkv_kernel
  .amdhsa_next_free_vgpr 160
  .amdhsa_next_free_sgpr 64
  .amdhsa_accum_offset 160
  .amdhsa_group_segment_fixed_size 0
  .amdhsa_kernarg_size 88
  .amdhsa_user_sgpr_count 2
  .amdhsa_user_sgpr_kernarg_segment_ptr 1
  .amdhsa_system_sgpr_workgroup_id_x 1
.end_amdhsa_kernel
.text
.globl mlp_kernel
.p2align 8
.type mlp_kernel,@function
mlp_kernel:
    s_cmp_ge_u32 s2, 256
    s_cbranch_scc1 m_end
    s_load_dwordx2 s[4:5], s[0:1], 80
    s_load_dwordx2 s[36:37], s[0:1], 16
    s_load_dwordx2 s[38:39], s[0:1], 32
    s_load_dwordx2 s[40:41], s[0:1], 48
    v_lshrrev_b32 v2, 6, v0
    v_and_b32 v3, 63, v0
    v_lshlrev_b32 v14, 4, v3
    v_readfirstlane_b32 s6, v2
    s_and_b32 s7, s2, 7
    s_lshr_b32 s8, s2, 3
    s_lshr_b32 s9, s8, 3
    s_lshl_b32 s7, s7, 2
    s_add_u32 s7, s7, s9
    s_and_b32 s10, s8, 7
    s_mov_b32 s15, 0x00020000
    s_mov_b32 s14, 0x10000000
    s_waitcnt lgkmcnt(0)
    s_mov_b32 s12, s4
    s_mov_b32 s13, s5
    s_and_b32 s11, s6, 1
    s_lshr_b32 s34, s6, 1
    s_lshl_b32 s9, s10, 3
    s_lshl_b32 s16, s11, 2
    s_add_u32 s9, s9, s16
    s_lshl_b32 s16, s7, 16
    s_lshl_b32 s17, s9, 10
    s_add_u32 s17, s17, s16
    s_lshl_b32 s18, s34, 4
    s_lshl_b32 s19, s11, 1
    s_add_u32 s18, s18, s19
    s_lshl_b32 s20, s18, 11
    s_lshl_b32 s18, s18, 10
    s_add_u32 s18, s18, s16
    s_add_u32 s19, s18, 0x400000
    s_add_u32 s18, s18, 0x200000
    s_add_u32 m0, s20, 0
    s_add_u32 s35, s18, 0
    buffer_load_dwordx4 v14, s[12:15], s35 offen lds
    s_add_u32 m0, s20, 1024
    s_add_u32 s35, s19, 0
    buffer_load_dwordx4 v14, s[12:15], s35 offen lds
    s_add_u32 m0, s20, 2048
    s_add_u32 s35, s18, 1024
    buffer_load_dwordx4 v14, s[12:15], s35 offen lds
    s_add_u32 m0, s20, 3072
    s_add_u32 s35, s19, 1024
    buffer_load_dwordx4 v14, s[12:15], s35 offen lds
    s_add_u32 s18, s18, 4096
    s_add_u32 s19, s19, 4096
    s_add_u32 s20, s20, 8192
    buffer_load_dwordx4 v[4:7], v14, s[12:15], s17 offen offset:0
    buffer_load_dwordx4 v[8:11], v14, s[12:15], s17 offen offset:1024
    buffer_load_dwordx4 v[16:19], v14, s[12:15], s17 offen offset:2048
    buffer_load_dwordx4 v[20:23], v14, s[12:15], s17 offen offset:3072
    s_mov_b32 s22, 0x0000ffff
    s_mov_b32 s23, 0x0000ffff
    v_and_b32 v2, 31, v3
    v_cmp_eq_u32 vcc, 16, v2
    v_mov_b32 v15, 0x3f803f80
    s_nop 0
    v_cndmask_b32 v2, 0, v15, vcc
    v_mov_b32 v144, v2
    v_mov_b32 v145, v2
    v_mov_b32 v146, v2
    v_mov_b32 v147, v2
    v_mov_b32 v148, v2
    v_mov_b32 v149, v2
    v_mov_b32 v150, v2
    v_mov_b32 v151, v2
    v_mov_b32 v152, v2
    v_mov_b32 v153, v2
    v_mov_b32 v154, v2
    v_mov_b32 v155, v2
    v_mov_b32 v156, v2
    v_mov_b32 v157, v2
    v_mov_b32 v158, v2
    v_mov_b32 v159, v2
    v_mov_b32 v64, 0
    v_mov_b32 v65, 0
    v_mov_b32 v66, 0
    v_mov_b32 v67, 0
    v_mov_b32 v68, 0
    v_mov_b32 v69, 0
    v_mov_b32 v70, 0
    v_mov_b32 v71, 0
    v_mov_b32 v72, 0
    v_mov_b32 v73, 0
    v_mov_b32 v74, 0
    v_mov_b32 v75, 0
    v_mov_b32 v76, 0
    v_mov_b32 v77, 0
    v_mov_b32 v78, 0
    v_mov_b32 v79, 0
    v_mov_b32 v80, 0
    v_mov_b32 v81, 0
    v_mov_b32 v82, 0
    v_mov_b32 v83, 0
    v_mov_b32 v84, 0
    v_mov_b32 v85, 0
    v_mov_b32 v86, 0
    v_mov_b32 v87, 0
    v_mov_b32 v88, 0
    v_mov_b32 v89, 0
    v_mov_b32 v90, 0
    v_mov_b32 v91, 0
    v_mov_b32 v92, 0
    v_mov_b32 v93, 0
    v_mov_b32 v94, 0
    v_mov_b32 v95, 0
    v_mov_b32 v96, 0
    v_mov_b32 v97, 0
    v_mov_b32 v98, 0
    v_mov_b32 v99, 0
    v_mov_b32 v100, 0
    v_mov_b32 v101, 0
    v_mov_b32 v102, 0
    v_mov_b32 v103, 0
    v_mov_b32 v104, 0
    v_mov_b32 v105, 0
    v_mov_b32 v106, 0
    v_mov_b32 v107, 0
    v_mov_b32 v108, 0
    v_mov_b32 v109, 0
    v_mov_b32 v110, 0
    v_mov_b32 v111, 0
    v_mov_b32 v112, 0
    v_mov_b32 v113, 0
    v_mov_b32 v114, 0
    v_mov_b32 v115, 0
    v_mov_b32 v116, 0
    v_mov_b32 v117, 0
    v_mov_b32 v118, 0
    v_mov_b32 v119, 0
    v_mov_b32 v120, 0
    v_mov_b32 v121, 0
    v_mov_b32 v122, 0
    v_mov_b32 v123, 0
    v_mov_b32 v124, 0
    v_mov_b32 v125, 0
    v_mov_b32 v126, 0
    v_mov_b32 v127, 0
    v_mov_b32 v132, 0
    v_mov_b32 v133, 0
    v_mov_b32 v134, 0
    v_mov_b32 v135, 0
    s_lshl_b32 s28, s11, 2
    s_add_u32 s28, s28, 152576
    v_mov_b32 v176, s28
    v_mov_b32 v177, 0
    s_cmp_lg_u32 s34, 0
    s_cbranch_scc1 fa_noinit
    ds_write_b32 v176, v177
    ds_write_b32 v176, v177 offset:16
    ds_write_b32 v176, v177 offset:32
fa_noinit:
    s_lshl_b32 s26, s9, 15
    s_lshl_b32 s28, s7, 10
    s_add_u32 s26, s26, s28
    s_add_u32 s26, s26, 0x600000
    s_lshl_b32 s24, s34, 15
    v_add_u32 v1, s24, v14
    s_waitcnt vmcnt(0) lgkmcnt(0)
    s_barrier
    ds_read_b128 v[136:139], v1
    s_mov_b64 exec, s[22:23]
    ds_read_b128 v[144:147], v1 offset:1024
    ds_read_b128 v[148:151], v1 offset:1280
    s_mov_b64 exec, -1
    s_mov_b32 s21, 0
    s_setprio 3
    s_waitcnt lgkmcnt(2)
    v_mfma_f32_32x32x16_bf16 v[32:47], v[136:139], v[4:7], 0
    s_add_u32 m0, s20, 0
    s_add_u32 s35, s18, 0
    buffer_load_dwordx4 v14, s[12:15], s35 offen lds
    s_add_u32 m0, s20, 1024
    s_add_u32 s35, s19, 0
    buffer_load_dwordx4 v14, s[12:15], s35 offen lds
    s_nop 5
    v_mfma_f32_32x32x16_bf16 v[48:63], v[136:139], v[8:11], 0
    v_exp_f32 v32, v32
    v_exp_f32 v33, v33
    v_exp_f32 v34, v34
    v_exp_f32 v35, v35
    v_mfma_f32_32x32x16_bf16 v[112:127], v[156:159], v[132:135], v[112:127]
    v_cvt_pk_bf16_f32 v128, v32, v33
    v_exp_f32 v36, v36
    v_exp_f32 v37, v37
    v_cvt_pk_bf16_f32 v129, v34, v35
    ds_read_b128 v[140:143], v1 offset:2048
    v_exp_f32 v38, v38
    v_exp_f32 v39, v39
    v_cvt_pk_bf16_f32 v130, v36, v37
    v_exp_f32 v40, v40
    v_cvt_pk_bf16_f32 v131, v38, v39
    v_exp_f32 v41, v41
    v_exp_f32 v42, v42
    s_waitcnt lgkmcnt(1)
    v_mfma_f32_32x32x16_bf16 v[64:79], v[144:147], v[128:131], v[64:79]
    v_exp_f32 v43, v43
    v_cvt_pk_bf16_f32 v132, v40, v41
    v_exp_f32 v44, v44
    v_exp_f32 v45, v45
    v_cvt_pk_bf16_f32 v133, v42, v43
    v_exp_f32 v46, v46
    v_exp_f32 v47, v47
    v_cvt_pk_bf16_f32 v134, v44, v45
    v_cvt_pk_bf16_f32 v135, v46, v47
    s_add_u32 m0, s20, 2048
    s_add_u32 s35, s18, 1024
    buffer_load_dwordx4 v14, s[12:15], s35 offen lds
    s_add_u32 m0, s20, 3072
    s_add_u32 s35, s19, 1024
    buffer_load_dwordx4 v14, s[12:15], s35 offen lds
    s_add_u32 s18, s18, 4096
    s_add_u32 s19, s19, 4096
    s_add_u32 s20, s20, 8192
    v_mfma_f32_32x32x16_bf16 v[32:47], v[136:139], v[16:19], 0
    v_exp_f32 v48, v48
    v_exp_f32 v49, v49
    v_exp_f32 v50, v50
    v_exp_f32 v51, v51
    v_mfma_f32_32x32x16_bf16 v[64:79], v[148:151], v[132:135], v[64:79]
    v_cvt_pk_bf16_f32 v128, v48, v49
    v_exp_f32 v52, v52
    v_exp_f32 v53, v53
    v_cvt_pk_bf16_f32 v129, v50, v51
    v_exp_f32 v54, v54
    v_exp_f32 v55, v55
    v_cvt_pk_bf16_f32 v130, v52, v53
    v_exp_f32 v56, v56
    v_cvt_pk_bf16_f32 v131, v54, v55
    v_exp_f32 v57, v57
    v_exp_f32 v58, v58
    v_mfma_f32_32x32x16_bf16 v[80:95], v[144:147], v[128:131], v[80:95]
    v_exp_f32 v59, v59
    v_cvt_pk_bf16_f32 v132, v56, v57
    s_mov_b64 exec, s[22:23]
    ds_read_b128 v[152:155], v1 offset:3072
    ds_read_b128 v[156:159], v1 offset:3328
    s_mov_b64 exec, -1
    v_exp_f32 v60, v60
    v_exp_f32 v61, v61
    v_cvt_pk_bf16_f32 v133, v58, v59
    v_exp_f32 v62, v62
    v_exp_f32 v63, v63
    v_cvt_pk_bf16_f32 v134, v60, v61
    v_cvt_pk_bf16_f32 v135, v62, v63
    s_add_u32 m0, s20, 0
    s_add_u32 s35, s18, 0
    buffer_load_dwordx4 v14, s[12:15], s35 offen lds
    s_add_u32 m0, s20, 1024
    s_add_u32 s35, s19, 0
    buffer_load_dwordx4 v14, s[12:15], s35 offen lds
    v_mfma_f32_32x32x16_bf16 v[48:63], v[136:139], v[20:23], 0
    v_exp_f32 v32, v32
    v_exp_f32 v33, v33
    v_exp_f32 v34, v34
    v_exp_f32 v35, v35
    v_mfma_f32_32x32x16_bf16 v[80:95], v[148:151], v[132:135], v[80:95]
    v_cvt_pk_bf16_f32 v128, v32, v33
    v_exp_f32 v36, v36
    v_exp_f32 v37, v37
    v_cvt_pk_bf16_f32 v129, v34, v35
    v_exp_f32 v38, v38
    v_exp_f32 v39, v39
    v_cvt_pk_bf16_f32 v130, v36, v37
    v_exp_f32 v40, v40
    v_cvt_pk_bf16_f32 v131, v38, v39
    v_exp_f32 v41, v41
    v_exp_f32 v42, v42
    v_mfma_f32_32x32x16_bf16 v[96:111], v[144:147], v[128:131], v[96:111]
    v_exp_f32 v43, v43
    v_cvt_pk_bf16_f32 v132, v40, v41
    v_exp_f32 v44, v44
    v_exp_f32 v45, v45
    v_cvt_pk_bf16_f32 v133, v42, v43
    v_exp_f32 v46, v46
    v_exp_f32 v47, v47
    v_cvt_pk_bf16_f32 v134, v44, v45
    v_cvt_pk_bf16_f32 v135, v46, v47
    s_add_u32 m0, s20, 2048
    s_add_u32 s35, s18, 1024
    buffer_load_dwordx4 v14, s[12:15], s35 offen lds
    s_add_u32 m0, s20, 3072
    s_add_u32 s35, s19, 1024
    buffer_load_dwordx4 v14, s[12:15], s35 offen lds
    s_add_u32 s18, s18, 4096
    s_add_u32 s19, s19, 4096
    s_add_u32 s20, s20, 8192
    s_waitcnt lgkmcnt(2)
    v_mfma_f32_32x32x16_bf16 v[32:47], v[140:143], v[4:7], 0
    v_exp_f32 v48, v48
    v_exp_f32 v49, v49
    v_exp_f32 v50, v50
    v_exp_f32 v51, v51
    v_mfma_f32_32x32x16_bf16 v[96:111], v[148:151], v[132:135], v[96:111]
    v_cvt_pk_bf16_f32 v128, v48, v49
    v_exp_f32 v52, v52
    v_exp_f32 v53, v53
    v_cvt_pk_bf16_f32 v129, v50, v51
    v_exp_f32 v54, v54
    v_exp_f32 v55, v55
    v_cvt_pk_bf16_f32 v130, v52, v53
    v_exp_f32 v56, v56
    v_cvt_pk_bf16_f32 v131, v54, v55
    v_exp_f32 v57, v57
    v_exp_f32 v58, v58
    v_mfma_f32_32x32x16_bf16 v[112:127], v[144:147], v[128:131], v[112:127]
    v_exp_f32 v59, v59
    v_cvt_pk_bf16_f32 v132, v56, v57
    v_exp_f32 v60, v60
    v_exp_f32 v61, v61
    v_cvt_pk_bf16_f32 v133, v58, v59
    v_exp_f32 v62, v62
    v_exp_f32 v63, v63
    v_cvt_pk_bf16_f32 v134, v60, v61
    v_cvt_pk_bf16_f32 v135, v62, v63
    s_add_u32 m0, s20, 0
    s_add_u32 s35, s18, 0
    buffer_load_dwordx4 v14, s[12:15], s35 offen lds
    s_add_u32 m0, s20, 1024
    s_add_u32 s35, s19, 0
    buffer_load_dwordx4 v14, s[12:15], s35 offen lds
    v_mfma_f32_32x32x16_bf16 v[48:63], v[140:143], v[8:11], 0
    v_exp_f32 v32, v32
    v_exp_f32 v33, v33
    v_exp_f32 v34, v34
    v_exp_f32 v35, v35
    v_mfma_f32_32x32x16_bf16 v[112:127], v[148:151], v[132:135], v[112:127]
    v_cvt_pk_bf16_f32 v128, v32, v33
    v_exp_f32 v36, v36
    v_exp_f32 v37, v37
    v_cvt_pk_bf16_f32 v129, v34, v35
    ds_read_b128 v[136:139], v1 offset:4096
    v_exp_f32 v38, v38
    v_exp_f32 v39, v39
    v_cvt_pk_bf16_f32 v130, v36, v37
    v_exp_f32 v40, v40
    v_cvt_pk_bf16_f32 v131, v38, v39
    v_exp_f32 v41, v41
    v_exp_f32 v42, v42
    s_waitcnt lgkmcnt(1)
    v_mfma_f32_32x32x16_bf16 v[64:79], v[152:155], v[128:131], v[64:79]
    v_exp_f32 v43, v43
    v_cvt_pk_bf16_f32 v132, v40, v41
    v_exp_f32 v44, v44
    v_exp_f32 v45, v45
    v_cvt_pk_bf16_f32 v133, v42, v43
    v_exp_f32 v46, v46
    v_exp_f32 v47, v47
    v_cvt_pk_bf16_f32 v134, v44, v45
    v_cvt_pk_bf16_f32 v135, v46, v47
    s_add_u32 m0, s20, 2048
    s_add_u32 s35, s18, 1024
    buffer_load_dwordx4 v14, s[12:15], s35 offen lds
    s_add_u32 m0, s20, 3072
    s_add_u32 s35, s19, 1024
    buffer_load_dwordx4 v14, s[12:15], s35 offen lds
    s_add_u32 s18, s18, 4096
    s_add_u32 s19, s19, 4096
    s_add_u32 s20, s20, 8192
    v_mfma_f32_32x32x16_bf16 v[32:47], v[140:143], v[16:19], 0
    v_exp_f32 v48, v48
    v_exp_f32 v49, v49
    v_exp_f32 v50, v50
    v_exp_f32 v51, v51
    v_mfma_f32_32x32x16_bf16 v[64:79], v[156:159], v[132:135], v[64:79]
    v_cvt_pk_bf16_f32 v128, v48, v49
    v_exp_f32 v52, v52
    v_exp_f32 v53, v53
    v_cvt_pk_bf16_f32 v129, v50, v51
    v_exp_f32 v54, v54
    v_exp_f32 v55, v55
    v_cvt_pk_bf16_f32 v130, v52, v53
    v_exp_f32 v56, v56
    v_cvt_pk_bf16_f32 v131, v54, v55
    v_exp_f32 v57, v57
    v_exp_f32 v58, v58
    v_mfma_f32_32x32x16_bf16 v[80:95], v[152:155], v[128:131], v[80:95]
    v_exp_f32 v59, v59
    v_cvt_pk_bf16_f32 v132, v56, v57
    s_mov_b64 exec, s[22:23]
    ds_read_b128 v[144:147], v1 offset:5120
    ds_read_b128 v[148:151], v1 offset:5376
    s_mov_b64 exec, -1
    v_exp_f32 v60, v60
    v_exp_f32 v61, v61
    v_cvt_pk_bf16_f32 v133, v58, v59
    v_exp_f32 v62, v62
    v_exp_f32 v63, v63
    v_cvt_pk_bf16_f32 v134, v60, v61
    v_cvt_pk_bf16_f32 v135, v62, v63
    v_mfma_f32_32x32x16_bf16 v[48:63], v[140:143], v[20:23], 0
    v_exp_f32 v32, v32
    v_exp_f32 v33, v33
    v_exp_f32 v34, v34
    v_exp_f32 v35, v35
    v_mfma_f32_32x32x16_bf16 v[80:95], v[156:159], v[132:135], v[80:95]
    v_cvt_pk_bf16_f32 v128, v32, v33
    v_exp_f32 v36, v36
    v_exp_f32 v37, v37
    v_cvt_pk_bf16_f32 v129, v34, v35
    v_exp_f32 v38, v38
    v_exp_f32 v39, v39
    v_cvt_pk_bf16_f32 v130, v36, v37
    v_exp_f32 v40, v40
    v_cvt_pk_bf16_f32 v131, v38, v39
    v_exp_f32 v41, v41
    v_exp_f32 v42, v42
    v_mfma_f32_32x32x16_bf16 v[96:111], v[152:155], v[128:131], v[96:111]
    v_exp_f32 v43, v43
    v_cvt_pk_bf16_f32 v132, v40, v41
    v_exp_f32 v44, v44
    v_exp_f32 v45, v45
    v_cvt_pk_bf16_f32 v133, v42, v43
    v_exp_f32 v46, v46
    v_exp_f32 v47, v47
    v_cvt_pk_bf16_f32 v134, v44, v45
    v_cvt_pk_bf16_f32 v135, v46, v47
    s_waitcnt lgkmcnt(2)
    v_mfma_f32_32x32x16_bf16 v[32:47], v[136:139], v[4:7], 0
    v_exp_f32 v48, v48
    v_exp_f32 v49, v49
    v_exp_f32 v50, v50
    v_exp_f32 v51, v51
    v_mfma_f32_32x32x16_bf16 v[96:111], v[156:159], v[132:135], v[96:111]
    v_cvt_pk_bf16_f32 v128, v48, v49
    v_exp_f32 v52, v52
    v_exp_f32 v53, v53
    v_cvt_pk_bf16_f32 v129, v50, v51
    v_exp_f32 v54, v54
    v_exp_f32 v55, v55
    v_cvt_pk_bf16_f32 v130, v52, v53
    v_exp_f32 v56, v56
    v_cvt_pk_bf16_f32 v131, v54, v55
    v_exp_f32 v57, v57
    v_exp_f32 v58, v58
    v_mfma_f32_32x32x16_bf16 v[112:127], v[152:155], v[128:131], v[112:127]
    v_exp_f32 v59, v59
    v_cvt_pk_bf16_f32 v132, v56, v57
    v_exp_f32 v60, v60
    v_exp_f32 v61, v61
    v_cvt_pk_bf16_f32 v133, v58, v59
    v_exp_f32 v62, v62
    v_exp_f32 v63, v63
    v_cvt_pk_bf16_f32 v134, v60, v61
    v_cvt_pk_bf16_f32 v135, v62, v63
    v_add_u32 v1, 4096, v1
    s_add_u32 s21, s21, 1
    s_branch fa_early
fa_loop:
    v_mfma_f32_32x32x16_bf16 v[48:63], v[136:139], v[8:11], 0
    v_exp_f32 v32, v32
    v_exp_f32 v33, v33
    v_exp_f32 v34, v34
    v_exp_f32 v35, v35
    v_mfma_f32_32x32x16_bf16 v[112:127], v[156:159], v[132:135], v[112:127]
    v_cvt_pk_bf16_f32 v128, v32, v33
    v_exp_f32 v36, v36
    v_exp_f32 v37, v37
    v_cvt_pk_bf16_f32 v129, v34, v35
    ds_read_b128 v[140:143], v1 offset:2048
    v_exp_f32 v38, v38
    v_exp_f32 v39, v39
    v_cvt_pk_bf16_f32 v130, v36, v37
    v_exp_f32 v40, v40
    v_cvt_pk_bf16_f32 v131, v38, v39
    v_exp_f32 v41, v41
    v_exp_f32 v42, v42
    s_waitcnt lgkmcnt(1)
    v_mfma_f32_32x32x16_bf16 v[64:79], v[144:147], v[128:131], v[64:79]
    v_exp_f32 v43, v43
    v_cvt_pk_bf16_f32 v132, v40, v41
    v_exp_f32 v44, v44
    v_exp_f32 v45, v45
    v_cvt_pk_bf16_f32 v133, v42, v43
    v_exp_f32 v46, v46
    v_exp_f32 v47, v47
    v_cvt_pk_bf16_f32 v134, v44, v45
    v_cvt_pk_bf16_f32 v135, v46, v47
    v_mfma_f32_32x32x16_bf16 v[32:47], v[136:139], v[16:19], 0
    v_exp_f32 v48, v48
    v_exp_f32 v49, v49
    v_exp_f32 v50, v50
    v_exp_f32 v51, v51
    v_mfma_f32_32x32x16_bf16 v[64:79], v[148:151], v[132:135], v[64:79]
    v_cvt_pk_bf16_f32 v128, v48, v49
    v_exp_f32 v52, v52
    v_exp_f32 v53, v53
    v_cvt_pk_bf16_f32 v129, v50, v51
    v_exp_f32 v54, v54
    v_exp_f32 v55, v55
    v_cvt_pk_bf16_f32 v130, v52, v53
    v_exp_f32 v56, v56
    v_cvt_pk_bf16_f32 v131, v54, v55
    v_exp_f32 v57, v57
    v_exp_f32 v58, v58
    v_mfma_f32_32x32x16_bf16 v[80:95], v[144:147], v[128:131], v[80:95]
    v_exp_f32 v59, v59
    v_cvt_pk_bf16_f32 v132, v56, v57
    s_mov_b64 exec, s[22:23]
    ds_read_b128 v[152:155], v1 offset:3072
    ds_read_b128 v[156:159], v1 offset:3328
    s_mov_b64 exec, -1
    v_exp_f32 v60, v60
    v_exp_f32 v61, v61
    v_cvt_pk_bf16_f32 v133, v58, v59
    v_exp_f32 v62, v62
    v_exp_f32 v63, v63
    v_cvt_pk_bf16_f32 v134, v60, v61
    v_cvt_pk_bf16_f32 v135, v62, v63
    v_mfma_f32_32x32x16_bf16 v[48:63], v[136:139], v[20:23], 0
    v_exp_f32 v32, v32
    v_exp_f32 v33, v33
    v_exp_f32 v34, v34
    v_exp_f32 v35, v35
    v_mfma_f32_32x32x16_bf16 v[80:95], v[148:151], v[132:135], v[80:95]
    v_cvt_pk_bf16_f32 v128, v32, v33
    v_exp_f32 v36, v36
    v_exp_f32 v37, v37
    v_cvt_pk_bf16_f32 v129, v34, v35
    v_exp_f32 v38, v38
    v_exp_f32 v39, v39
    v_cvt_pk_bf16_f32 v130, v36, v37
    v_exp_f32 v40, v40
    v_cvt_pk_bf16_f32 v131, v38, v39
    v_exp_f32 v41, v41
    v_exp_f32 v42, v42
    v_mfma_f32_32x32x16_bf16 v[96:111], v[144:147], v[128:131], v[96:111]
    v_exp_f32 v43, v43
    v_cvt_pk_bf16_f32 v132, v40, v41
    v_exp_f32 v44, v44
    v_exp_f32 v45, v45
    v_cvt_pk_bf16_f32 v133, v42, v43
    v_exp_f32 v46, v46
    v_exp_f32 v47, v47
    v_cvt_pk_bf16_f32 v134, v44, v45
    v_cvt_pk_bf16_f32 v135, v46, v47
    s_waitcnt lgkmcnt(2)
    v_mfma_f32_32x32x16_bf16 v[32:47], v[140:143], v[4:7], 0
    v_exp_f32 v48, v48
    v_exp_f32 v49, v49
    v_exp_f32 v50, v50
    v_exp_f32 v51, v51
    v_mfma_f32_32x32x16_bf16 v[96:111], v[148:151], v[132:135], v[96:111]
    v_cvt_pk_bf16_f32 v128, v48, v49
    v_exp_f32 v52, v52
    v_exp_f32 v53, v53
    v_cvt_pk_bf16_f32 v129, v50, v51
    v_exp_f32 v54, v54
    v_exp_f32 v55, v55
    v_cvt_pk_bf16_f32 v130, v52, v53
    v_exp_f32 v56, v56
    v_cvt_pk_bf16_f32 v131, v54, v55
    v_exp_f32 v57, v57
    v_exp_f32 v58, v58
    v_mfma_f32_32x32x16_bf16 v[112:127], v[144:147], v[128:131], v[112:127]
    v_exp_f32 v59, v59
    v_cvt_pk_bf16_f32 v132, v56, v57
    v_exp_f32 v60, v60
    v_exp_f32 v61, v61
    v_cvt_pk_bf16_f32 v133, v58, v59
    v_exp_f32 v62, v62
    v_exp_f32 v63, v63
    v_cvt_pk_bf16_f32 v134, v60, v61
    v_cvt_pk_bf16_f32 v135, v62, v63
    v_mfma_f32_32x32x16_bf16 v[48:63], v[140:143], v[8:11], 0
    v_exp_f32 v32, v32
    v_exp_f32 v33, v33
    v_exp_f32 v34, v34
    v_exp_f32 v35, v35
    v_mfma_f32_32x32x16_bf16 v[112:127], v[148:151], v[132:135], v[112:127]
    v_cvt_pk_bf16_f32 v128, v32, v33
    v_exp_f32 v36, v36
    v_exp_f32 v37, v37
    v_cvt_pk_bf16_f32 v129, v34, v35
    ds_read_b128 v[136:139], v1 offset:4096
    v_exp_f32 v38, v38
    v_exp_f32 v39, v39
    v_cvt_pk_bf16_f32 v130, v36, v37
    v_exp_f32 v40, v40
    v_cvt_pk_bf16_f32 v131, v38, v39
    v_exp_f32 v41, v41
    v_exp_f32 v42, v42
    s_waitcnt lgkmcnt(1)
    v_mfma_f32_32x32x16_bf16 v[64:79], v[152:155], v[128:131], v[64:79]
    v_exp_f32 v43, v43
    v_cvt_pk_bf16_f32 v132, v40, v41
    v_exp_f32 v44, v44
    v_exp_f32 v45, v45
    v_cvt_pk_bf16_f32 v133, v42, v43
    v_exp_f32 v46, v46
    v_exp_f32 v47, v47
    v_cvt_pk_bf16_f32 v134, v44, v45
    v_cvt_pk_bf16_f32 v135, v46, v47
    v_mfma_f32_32x32x16_bf16 v[32:47], v[140:143], v[16:19], 0
    v_exp_f32 v48, v48
    v_exp_f32 v49, v49
    v_exp_f32 v50, v50
    v_exp_f32 v51, v51
    v_mfma_f32_32x32x16_bf16 v[64:79], v[156:159], v[132:135], v[64:79]
    v_cvt_pk_bf16_f32 v128, v48, v49
    v_exp_f32 v52, v52
    v_exp_f32 v53, v53
    v_cvt_pk_bf16_f32 v129, v50, v51
    v_exp_f32 v54, v54
    v_exp_f32 v55, v55
    v_cvt_pk_bf16_f32 v130, v52, v53
    v_exp_f32 v56, v56
    v_cvt_pk_bf16_f32 v131, v54, v55
    v_exp_f32 v57, v57
    v_exp_f32 v58, v58
    v_mfma_f32_32x32x16_bf16 v[80:95], v[152:155], v[128:131], v[80:95]
    v_exp_f32 v59, v59
    v_cvt_pk_bf16_f32 v132, v56, v57
    s_mov_b64 exec, s[22:23]
    ds_read_b128 v[144:147], v1 offset:5120
    ds_read_b128 v[148:151], v1 offset:5376
    s_mov_b64 exec, -1
    v_exp_f32 v60, v60
    v_exp_f32 v61, v61
    v_cvt_pk_bf16_f32 v133, v58, v59
    v_exp_f32 v62, v62
    v_exp_f32 v63, v63
    v_cvt_pk_bf16_f32 v134, v60, v61
    v_cvt_pk_bf16_f32 v135, v62, v63
    v_mfma_f32_32x32x16_bf16 v[48:63], v[140:143], v[20:23], 0
    v_exp_f32 v32, v32
    v_exp_f32 v33, v33
    v_exp_f32 v34, v34
    v_exp_f32 v35, v35
    v_mfma_f32_32x32x16_bf16 v[80:95], v[156:159], v[132:135], v[80:95]
    v_cvt_pk_bf16_f32 v128, v32, v33
    v_exp_f32 v36, v36
    v_exp_f32 v37, v37
    v_cvt_pk_bf16_f32 v129, v34, v35
    v_exp_f32 v38, v38
    v_exp_f32 v39, v39
    v_cvt_pk_bf16_f32 v130, v36, v37
    v_exp_f32 v40, v40
    v_cvt_pk_bf16_f32 v131, v38, v39
    v_exp_f32 v41, v41
    v_exp_f32 v42, v42
    v_mfma_f32_32x32x16_bf16 v[96:111], v[152:155], v[128:131], v[96:111]
    v_exp_f32 v43, v43
    v_cvt_pk_bf16_f32 v132, v40, v41
    v_exp_f32 v44, v44
    v_exp_f32 v45, v45
    v_cvt_pk_bf16_f32 v133, v42, v43
    v_exp_f32 v46, v46
    v_exp_f32 v47, v47
    v_cvt_pk_bf16_f32 v134, v44, v45
    v_cvt_pk_bf16_f32 v135, v46, v47
    s_waitcnt lgkmcnt(2)
    v_mfma_f32_32x32x16_bf16 v[32:47], v[136:139], v[4:7], 0
    v_exp_f32 v48, v48
    v_exp_f32 v49, v49
    v_exp_f32 v50, v50
    v_exp_f32 v51, v51
    v_mfma_f32_32x32x16_bf16 v[96:111], v[156:159], v[132:135], v[96:111]
    v_cvt_pk_bf16_f32 v128, v48, v49
    v_exp_f32 v52, v52
    v_exp_f32 v53, v53
    v_cvt_pk_bf16_f32 v129, v50, v51
    v_exp_f32 v54, v54
    v_exp_f32 v55, v55
    v_cvt_pk_bf16_f32 v130, v52, v53
    v_exp_f32 v56, v56
    v_cvt_pk_bf16_f32 v131, v54, v55
    v_exp_f32 v57, v57
    v_exp_f32 v58, v58
    v_mfma_f32_32x32x16_bf16 v[112:127], v[152:155], v[128:131], v[112:127]
    v_exp_f32 v59, v59
    v_cvt_pk_bf16_f32 v132, v56, v57
    v_exp_f32 v60, v60
    v_exp_f32 v61, v61
    v_cvt_pk_bf16_f32 v133, v58, v59
    v_exp_f32 v62, v62
    v_exp_f32 v63, v63
    v_cvt_pk_bf16_f32 v134, v60, v61
    v_cvt_pk_bf16_f32 v135, v62, v63
    v_add_u32 v1, 4096, v1
    s_add_u32 s21, s21, 1
fa_cont:
    s_cmp_eq_u32 s21, 2
    s_cbranch_scc0 fa_pr1
    s_setprio 2
fa_pr1:
    s_cmp_eq_u32 s21, 4
    s_cbranch_scc0 fa_pr2
    s_setprio 1
fa_pr2:
    s_cmp_eq_u32 s21, 6
    s_cbranch_scc0 fa_pr3
    s_setprio 0
fa_pr3:
    s_cmp_lt_u32 s21, 8
    s_cbranch_scc1 fa_loop
    v_mfma_f32_32x32x16_bf16 v[112:127], v[156:159], v[132:135], v[112:127]
    s_mul_i32 s28, s11, 8704
    s_add_u32 s28, s28, 135168
    v_add_u32 v2, s28, v14
    v_and_b32 v15, 31, v3
    v_lshlrev_b32 v15, 2, v15
    v_add_u32 v15, s28, v15
    s_waitcnt lgkmcnt(0)
    s_nop 7
    s_nop 1
    v_add_u32 v179, 16, v176
    v_add_u32 v180, 32, v176
    s_cmp_eq_u32 s34, 0
    s_cbranch_scc0 fa_k1
    ds_write_b128 v2, v[64:67] offset:0
    ds_write_b128 v2, v[68:71] offset:1024
    ds_write_b128 v2, v[80:83] offset:2048
    ds_write_b128 v2, v[84:87] offset:3072
    ds_write_b128 v2, v[96:99] offset:4096
    ds_write_b128 v2, v[100:103] offset:5120
    ds_write_b128 v2, v[112:115] offset:6144
    ds_write_b128 v2, v[116:119] offset:7168
    s_mov_b32 exec_hi, 0
    ds_write_b32 v15, v72 offset:8192
    ds_write_b32 v15, v88 offset:8320
    ds_write_b32 v15, v104 offset:8448
    ds_write_b32 v15, v120 offset:8576
    s_mov_b64 exec, -1
    v_mov_b32 v177, 1
    s_waitcnt lgkmcnt(0)
    ds_write_b32 v176, v177
    s_waitcnt lgkmcnt(0)
    s_branch fa_done
fa_k1:
    s_cmp_eq_u32 s34, 1
    s_cbranch_scc0 fa_k2
fa_s1:
    ds_read_b32 v177, v176
    s_waitcnt lgkmcnt(0)
    v_readfirstlane_b32 s28, v177
    s_cmp_ge_u32 s28, 1
    s_cbranch_scc1 fa_s1d
    s_sleep 1
    s_branch fa_s1
fa_s1d:
    ds_read_b128 v[32:35], v2 offset:0
    ds_read_b128 v[36:39], v2 offset:1024
    ds_read_b32 v40, v15 offset:8192
    ds_read_b128 v[48:51], v2 offset:2048
    ds_read_b128 v[52:55], v2 offset:3072
    ds_read_b32 v56, v15 offset:8320
    s_waitcnt lgkmcnt(0)
    v_add_f32 v64, v64, v32
    v_add_f32 v65, v65, v33
    v_add_f32 v66, v66, v34
    v_add_f32 v67, v67, v35
    v_add_f32 v68, v68, v36
    v_add_f32 v69, v69, v37
    v_add_f32 v70, v70, v38
    v_add_f32 v71, v71, v39
    v_add_f32 v72, v72, v40
    v_add_f32 v80, v80, v48
    v_add_f32 v81, v81, v49
    v_add_f32 v82, v82, v50
    v_add_f32 v83, v83, v51
    v_add_f32 v84, v84, v52
    v_add_f32 v85, v85, v53
    v_add_f32 v86, v86, v54
    v_add_f32 v87, v87, v55
    v_add_f32 v88, v88, v56
    ds_read_b128 v[32:35], v2 offset:4096
    ds_read_b128 v[36:39], v2 offset:5120
    ds_read_b32 v40, v15 offset:8448
    ds_read_b128 v[48:51], v2 offset:6144
    ds_read_b128 v[52:55], v2 offset:7168
    ds_read_b32 v56, v15 offset:8576
    s_waitcnt lgkmcnt(0)
    v_add_f32 v96, v96, v32
    v_add_f32 v97, v97, v33
    v_add_f32 v98, v98, v34
    v_add_f32 v99, v99, v35
    v_add_f32 v100, v100, v36
    v_add_f32 v101, v101, v37
    v_add_f32 v102, v102, v38
    v_add_f32 v103, v103, v39
    v_add_f32 v104, v104, v40
    v_add_f32 v112, v112, v48
    v_add_f32 v113, v113, v49
    v_add_f32 v114, v114, v50
    v_add_f32 v115, v115, v51
    v_add_f32 v116, v116, v52
    v_add_f32 v117, v117, v53
    v_add_f32 v118, v118, v54
    v_add_f32 v119, v119, v55
    v_add_f32 v120, v120, v56
    ds_write_b128 v2, v[64:67] offset:0
    ds_write_b128 v2, v[68:71] offset:1024
    ds_write_b128 v2, v[80:83] offset:2048
    ds_write_b128 v2, v[84:87] offset:3072
    ds_write_b128 v2, v[96:99] offset:4096
    ds_write_b128 v2, v[100:103] offset:5120
    ds_write_b128 v2, v[112:115] offset:6144
    ds_write_b128 v2, v[116:119] offset:7168
    s_mov_b32 exec_hi, 0
    ds_write_b32 v15, v72 offset:8192
    ds_write_b32 v15, v88 offset:8320
    ds_write_b32 v15, v104 offset:8448
    ds_write_b32 v15, v120 offset:8576
    s_mov_b64 exec, -1
    v_mov_b32 v177, 2
    s_waitcnt lgkmcnt(0)
    ds_write_b32 v176, v177
    s_waitcnt lgkmcnt(0)
    s_branch fa_done
fa_k2:
fa_s2:
    ds_read_b32 v177, v176
    s_waitcnt lgkmcnt(0)
    v_readfirstlane_b32 s28, v177
    s_cmp_ge_u32 s28, 2
    s_cbranch_scc1 fa_s2d
    s_sleep 1
    s_branch fa_s2
fa_s2d:
    s_cmp_eq_u32 s34, 2
    s_cbranch_scc0 fa_k3
    ds_read_b128 v[32:35], v2 offset:0
    ds_read_b128 v[36:39], v2 offset:1024
    ds_read_b32 v40, v15 offset:8192
    ds_read_b128 v[48:51], v2 offset:2048
    ds_read_b128 v[52:55], v2 offset:3072
    ds_read_b32 v56, v15 offset:8320
    s_waitcnt lgkmcnt(0)
    v_add_f32 v64, v64, v32
    v_add_f32 v65, v65, v33
    v_add_f32 v66, v66, v34
    v_add_f32 v67, v67, v35
    v_add_f32 v68, v68, v36
    v_add_f32 v69, v69, v37
    v_add_f32 v70, v70, v38
    v_add_f32 v71, v71, v39
    v_add_f32 v72, v72, v40
    v_add_f32 v80, v80, v48
    v_add_f32 v81, v81, v49
    v_add_f32 v82, v82, v50
    v_add_f32 v83, v83, v51
    v_add_f32 v84, v84, v52
    v_add_f32 v85, v85, v53
    v_add_f32 v86, v86, v54
    v_add_f32 v87, v87, v55
    v_add_f32 v88, v88, v56
    ds_write_b128 v2, v[96:99] offset:0
    ds_write_b128 v2, v[100:103] offset:1024
    ds_write_b128 v2, v[112:115] offset:2048
    ds_write_b128 v2, v[116:119] offset:3072
    s_mov_b32 exec_hi, 0
    ds_write_b32 v15, v104 offset:8192
    ds_write_b32 v15, v120 offset:8320
    s_mov_b64 exec, -1
    v_mov_b32 v177, 1
    s_waitcnt lgkmcnt(0)
    ds_write_b32 v179, v177
    s_waitcnt lgkmcnt(0)
fa_s3:
    ds_read_b32 v177, v180
    s_waitcnt lgkmcnt(0)
    v_readfirstlane_b32 s28, v177
    s_cmp_ge_u32 s28, 1
    s_cbranch_scc1 fa_s3d
    s_sleep 1
    s_branch fa_s3
fa_s3d:
    ds_read_b128 v[32:35], v2 offset:4096
    ds_read_b128 v[36:39], v2 offset:5120
    ds_read_b32 v40, v15 offset:8448
    ds_read_b128 v[48:51], v2 offset:6144
    ds_read_b128 v[52:55], v2 offset:7168
    ds_read_b32 v56, v15 offset:8576
    s_waitcnt lgkmcnt(0)
    v_add_f32 v64, v64, v32
    v_add_f32 v65, v65, v33
    v_add_f32 v66, v66, v34
    v_add_f32 v67, v67, v35
    v_add_f32 v68, v68, v36
    v_add_f32 v69, v69, v37
    v_add_f32 v70, v70, v38
    v_add_f32 v71, v71, v39
    v_add_f32 v72, v72, v40
    v_add_f32 v80, v80, v48
    v_add_f32 v81, v81, v49
    v_add_f32 v82, v82, v50
    v_add_f32 v83, v83, v51
    v_add_f32 v84, v84, v52
    v_add_f32 v85, v85, v53
    v_add_f32 v86, v86, v54
    v_add_f32 v87, v87, v55
    v_add_f32 v88, v88, v56
    s_branch fa_lastAB
fa_k3:
    ds_read_b128 v[32:35], v2 offset:4096
    ds_read_b128 v[36:39], v2 offset:5120
    ds_read_b32 v40, v15 offset:8448
    ds_read_b128 v[48:51], v2 offset:6144
    ds_read_b128 v[52:55], v2 offset:7168
    ds_read_b32 v56, v15 offset:8576
    s_waitcnt lgkmcnt(0)
    v_add_f32 v96, v96, v32
    v_add_f32 v97, v97, v33
    v_add_f32 v98, v98, v34
    v_add_f32 v99, v99, v35
    v_add_f32 v100, v100, v36
    v_add_f32 v101, v101, v37
    v_add_f32 v102, v102, v38
    v_add_f32 v103, v103, v39
    v_add_f32 v104, v104, v40
    v_add_f32 v112, v112, v48
    v_add_f32 v113, v113, v49
    v_add_f32 v114, v114, v50
    v_add_f32 v115, v115, v51
    v_add_f32 v116, v116, v52
    v_add_f32 v117, v117, v53
    v_add_f32 v118, v118, v54
    v_add_f32 v119, v119, v55
    v_add_f32 v120, v120, v56
    ds_write_b128 v2, v[64:67] offset:4096
    ds_write_b128 v2, v[68:71] offset:5120
    ds_write_b128 v2, v[80:83] offset:6144
    ds_write_b128 v2, v[84:87] offset:7168
    s_mov_b32 exec_hi, 0
    ds_write_b32 v15, v72 offset:8448
    ds_write_b32 v15, v88 offset:8576
    s_mov_b64 exec, -1
    v_mov_b32 v177, 1
    s_waitcnt lgkmcnt(0)
    ds_write_b32 v180, v177
    s_waitcnt lgkmcnt(0)
fa_s4:
    ds_read_b32 v177, v179
    s_waitcnt lgkmcnt(0)
    v_readfirstlane_b32 s28, v177
    s_cmp_ge_u32 s28, 1
    s_cbranch_scc1 fa_s4d
    s_sleep 1
    s_branch fa_s4
fa_s4d:
    ds_read_b128 v[32:35], v2 offset:0
    ds_read_b128 v[36:39], v2 offset:1024
    ds_read_b32 v40, v15 offset:8192
    ds_read_b128 v[48:51], v2 offset:2048
    ds_read_b128 v[52:55], v2 offset:3072
    ds_read_b32 v56, v15 offset:8320
    s_waitcnt lgkmcnt(0)
    v_add_f32 v96, v96, v32
    v_add_f32 v97, v97, v33
    v_add_f32 v98, v98, v34
    v_add_f32 v99, v99, v35
    v_add_f32 v100, v100, v36
    v_add_f32 v101, v101, v37
    v_add_f32 v102, v102, v38
    v_add_f32 v103, v103, v39
    v_add_f32 v104, v104, v40
    v_add_f32 v112, v112, v48
    v_add_f32 v113, v113, v49
    v_add_f32 v114, v114, v50
    v_add_f32 v115, v115, v51
    v_add_f32 v116, v116, v52
    v_add_f32 v117, v117, v53
    v_add_f32 v118, v118, v54
    v_add_f32 v119, v119, v55
    v_add_f32 v120, v120, v56
    v_mov_b32 v64, v96
    v_mov_b32 v65, v97
    v_mov_b32 v66, v98
    v_mov_b32 v67, v99
    v_mov_b32 v68, v100
    v_mov_b32 v69, v101
    v_mov_b32 v70, v102
    v_mov_b32 v71, v103
    v_mov_b32 v72, v104
    v_mov_b32 v4, v16
    v_mov_b32 v5, v17
    v_mov_b32 v6, v18
    v_mov_b32 v7, v19
    v_mov_b32 v80, v112
    v_mov_b32 v81, v113
    v_mov_b32 v82, v114
    v_mov_b32 v83, v115
    v_mov_b32 v84, v116
    v_mov_b32 v85, v117
    v_mov_b32 v86, v118
    v_mov_b32 v87, v119
    v_mov_b32 v88, v120
    v_mov_b32 v8, v20
    v_mov_b32 v9, v21
    v_mov_b32 v10, v22
    v_mov_b32 v11, v23
    s_add_u32 s26, s26, 65536
fa_lastAB:
    v_mov_b32 v73, v72
    v_mov_b32 v89, v88
    s_nop 1
    v_permlane32_swap_b32 v72, v73
    v_permlane32_swap_b32 v88, v89
    v_mul_f32 v178, 0, v64
    v_fmac_f32 v178, 0, v65
    v_fmac_f32 v178, 0, v66
    v_fmac_f32 v178, 0, v67
    v_fmac_f32 v178, 0, v68
    v_fmac_f32 v178, 0, v69
    v_fmac_f32 v178, 0, v70
    v_fmac_f32 v178, 0, v71
    v_fmac_f32 v178, 0, v80
    v_fmac_f32 v178, 0, v81
    v_fmac_f32 v178, 0, v82
    v_fmac_f32 v178, 0, v83
    v_fmac_f32 v178, 0, v84
    v_fmac_f32 v178, 0, v85
    v_fmac_f32 v178, 0, v86
    v_fmac_f32 v178, 0, v87
    s_mov_b32 s28, 0xd800000
    s_mov_b32 s29, 0x71800000
    v_cmp_eq_f32 s[30:31], 0, v178
    v_cmp_le_f32 s[32:33], s28, v72
    v_cmp_ge_f32 vcc, s29, v72
    s_nop 1
    s_and_b64 s[30:31], s[30:31], s[32:33]
    s_and_b64 s[30:31], s[30:31], vcc
    v_cmp_le_f32 s[32:33], s28, v88
    v_cmp_ge_f32 vcc, s29, v88
    s_nop 1
    s_and_b64 s[30:31], s[30:31], s[32:33]
    s_and_b64 s[30:31], s[30:31], vcc
    s_cmp_eq_u64 s[30:31], -1
    s_cbranch_scc1 fa_fin
    v_mov_b32 v1, v14
    v_mov_b32 v2, 0xff800000
    s_mov_b32 s21, 0
fa_fb0a:
    ds_read_b128 v[136:139], v1
    s_waitcnt lgkmcnt(0)
    v_mfma_f32_32x32x16_bf16 v[32:47], v[136:139], v[4:7], 0
    v_add_u32 v1, 2048, v1
    s_nop 7
    s_nop 7
    v_max3_f32 v2, v2, v32, v33
    v_max3_f32 v2, v2, v34, v35
    v_max3_f32 v2, v2, v36, v37
    v_max3_f32 v2, v2, v38, v39
    v_max3_f32 v2, v2, v40, v41
    v_max3_f32 v2, v2, v42, v43
    v_max3_f32 v2, v2, v44, v45
    v_max3_f32 v2, v2, v46, v47
    s_add_u32 s21, s21, 1
    s_cmp_lt_u32 s21, 64
    s_cbranch_scc1 fa_fb0a
    v_mov_b32 v15, v2
    s_nop 1
    v_permlane32_swap_b32 v2, v15
    s_nop 1
    v_max_f32 v2, v2, v15
    v_sub_f32 v2, 0, v2
    v_mov_b32 v160, v2
    v_mov_b32 v64, 0
    v_mov_b32 v161, v2
    v_mov_b32 v65, 0
    v_mov_b32 v162, v2
    v_mov_b32 v66, 0
    v_mov_b32 v163, v2
    v_mov_b32 v67, 0
    v_mov_b32 v164, v2
    v_mov_b32 v68, 0
    v_mov_b32 v165, v2
    v_mov_b32 v69, 0
    v_mov_b32 v166, v2
    v_mov_b32 v70, 0
    v_mov_b32 v167, v2
    v_mov_b32 v71, 0
    v_mov_b32 v168, v2
    v_mov_b32 v72, 0
    v_mov_b32 v169, v2
    v_mov_b32 v73, 0
    v_mov_b32 v170, v2
    v_mov_b32 v74, 0
    v_mov_b32 v171, v2
    v_mov_b32 v75, 0
    v_mov_b32 v172, v2
    v_mov_b32 v76, 0
    v_mov_b32 v173, v2
    v_mov_b32 v77, 0
    v_mov_b32 v174, v2
    v_mov_b32 v78, 0
    v_mov_b32 v175, v2
    v_mov_b32 v79, 0
    v_mov_b32 v1, v14
    s_mov_b32 s21, 0
fa_fb0b:
    ds_read_b128 v[136:139], v1
    s_mov_b64 exec, s[22:23]
    ds_read_b128 v[144:147], v1 offset:1024
    ds_read_b128 v[148:151], v1 offset:1280
    s_mov_b64 exec, -1
    s_waitcnt lgkmcnt(0)
    v_mfma_f32_32x32x16_bf16 v[32:47], v[136:139], v[4:7], v[160:175]
    v_add_u32 v1, 2048, v1
    s_nop 7
    s_nop 7
    v_exp_f32 v32, v32
    v_exp_f32 v33, v33
    v_exp_f32 v34, v34
    v_exp_f32 v35, v35
    v_exp_f32 v36, v36
    v_exp_f32 v37, v37
    v_exp_f32 v38, v38
    v_exp_f32 v39, v39
    v_exp_f32 v40, v40
    v_exp_f32 v41, v41
    v_exp_f32 v42, v42
    v_exp_f32 v43, v43
    v_exp_f32 v44, v44
    v_exp_f32 v45, v45
    v_exp_f32 v46, v46
    v_exp_f32 v47, v47
    s_nop 0
    v_cvt_pk_bf16_f32 v128, v32, v33
    v_cvt_pk_bf16_f32 v129, v34, v35
    v_cvt_pk_bf16_f32 v130, v36, v37
    v_cvt_pk_bf16_f32 v131, v38, v39
    v_cvt_pk_bf16_f32 v132, v40, v41
    v_cvt_pk_bf16_f32 v133, v42, v43
    v_cvt_pk_bf16_f32 v134, v44, v45
    v_cvt_pk_bf16_f32 v135, v46, v47
    s_nop 1
    v_mfma_f32_32x32x16_bf16 v[64:79], v[144:147], v[128:131], v[64:79]
    v_mfma_f32_32x32x16_bf16 v[64:79], v[148:151], v[132:135], v[64:79]
    s_add_u32 s21, s21, 1
    s_cmp_lt_u32 s21, 64
    s_cbranch_scc1 fa_fb0b
    s_nop 7
    s_nop 7
    v_mov_b32 v73, v72
    s_nop 1
    v_permlane32_swap_b32 v72, v73
    s_nop 1
    v_mov_b32 v1, v14
    v_mov_b32 v2, 0xff800000
    s_mov_b32 s21, 0
fa_fb1a:
    ds_read_b128 v[136:139], v1
    s_waitcnt lgkmcnt(0)
    v_mfma_f32_32x32x16_bf16 v[32:47], v[136:139], v[8:11], 0
    v_add_u32 v1, 2048, v1
    s_nop 7
    s_nop 7
    v_max3_f32 v2, v2, v32, v33
    v_max3_f32 v2, v2, v34, v35
    v_max3_f32 v2, v2, v36, v37
    v_max3_f32 v2, v2, v38, v39
    v_max3_f32 v2, v2, v40, v41
    v_max3_f32 v2, v2, v42, v43
    v_max3_f32 v2, v2, v44, v45
    v_max3_f32 v2, v2, v46, v47
    s_add_u32 s21, s21, 1
    s_cmp_lt_u32 s21, 64
    s_cbranch_scc1 fa_fb1a
    v_mov_b32 v15, v2
    s_nop 1
    v_permlane32_swap_b32 v2, v15
    s_nop 1
    v_max_f32 v2, v2, v15
    v_sub_f32 v2, 0, v2
    v_mov_b32 v160, v2
    v_mov_b32 v80, 0
    v_mov_b32 v161, v2
    v_mov_b32 v81, 0
    v_mov_b32 v162, v2
    v_mov_b32 v82, 0
    v_mov_b32 v163, v2
    v_mov_b32 v83, 0
    v_mov_b32 v164, v2
    v_mov_b32 v84, 0
    v_mov_b32 v165, v2
    v_mov_b32 v85, 0
    v_mov_b32 v166, v2
    v_mov_b32 v86, 0
    v_mov_b32 v167, v2
    v_mov_b32 v87, 0
    v_mov_b32 v168, v2
    v_mov_b32 v88, 0
    v_mov_b32 v169, v2
    v_mov_b32 v89, 0
    v_mov_b32 v170, v2
    v_mov_b32 v90, 0
    v_mov_b32 v171, v2
    v_mov_b32 v91, 0
    v_mov_b32 v172, v2
    v_mov_b32 v92, 0
    v_mov_b32 v173, v2
    v_mov_b32 v93, 0
    v_mov_b32 v174, v2
    v_mov_b32 v94, 0
    v_mov_b32 v175, v2
    v_mov_b32 v95, 0
    v_mov_b32 v1, v14
    s_mov_b32 s21, 0
fa_fb1b:
    ds_read_b128 v[136:139], v1
    s_mov_b64 exec, s[22:23]
    ds_read_b128 v[144:147], v1 offset:1024
    ds_read_b128 v[148:151], v1 offset:1280
    s_mov_b64 exec, -1
    s_waitcnt lgkmcnt(0)
    v_mfma_f32_32x32x16_bf16 v[32:47], v[136:139], v[8:11], v[160:175]
    v_add_u32 v1, 2048, v1
    s_nop 7
    s_nop 7
    v_exp_f32 v32, v32
    v_exp_f32 v33, v33
    v_exp_f32 v34, v34
    v_exp_f32 v35, v35
    v_exp_f32 v36, v36
    v_exp_f32 v37, v37
    v_exp_f32 v38, v38
    v_exp_f32 v39, v39
    v_exp_f32 v40, v40
    v_exp_f32 v41, v41
    v_exp_f32 v42, v42
    v_exp_f32 v43, v43
    v_exp_f32 v44, v44
    v_exp_f32 v45, v45
    v_exp_f32 v46, v46
    v_exp_f32 v47, v47
    s_nop 0
    v_cvt_pk_bf16_f32 v128, v32, v33
    v_cvt_pk_bf16_f32 v129, v34, v35
    v_cvt_pk_bf16_f32 v130, v36, v37
    v_cvt_pk_bf16_f32 v131, v38, v39
    v_cvt_pk_bf16_f32 v132, v40, v41
    v_cvt_pk_bf16_f32 v133, v42, v43
    v_cvt_pk_bf16_f32 v134, v44, v45
    v_cvt_pk_bf16_f32 v135, v46, v47
    s_nop 1
    v_mfma_f32_32x32x16_bf16 v[80:95], v[144:147], v[128:131], v[80:95]
    v_mfma_f32_32x32x16_bf16 v[80:95], v[148:151], v[132:135], v[80:95]
    s_add_u32 s21, s21, 1
    s_cmp_lt_u32 s21, 64
    s_cbranch_scc1 fa_fb1b
    s_nop 7
    s_nop 7
    v_mov_b32 v89, v88
    s_nop 1
    v_permlane32_swap_b32 v88, v89
    s_nop 1
fa_fin:
    v_rcp_f32 v178, v72
    v_rcp_f32 v179, v88
    s_nop 0
    v_mul_f32 v64, v64, v178
    v_mul_f32 v65, v65, v178
    v_mul_f32 v66, v66, v178
    v_mul_f32 v67, v67, v178
    v_mul_f32 v68, v68, v178
    v_mul_f32 v69, v69, v178
    v_mul_f32 v70, v70, v178
    v_mul_f32 v71, v71, v178
    v_cvt_pk_bf16_f32 v32, v64, v65
    v_cvt_pk_bf16_f32 v33, v66, v67
    v_cvt_pk_bf16_f32 v34, v68, v69
    v_cvt_pk_bf16_f32 v35, v70, v71
    v_mul_f32 v80, v80, v179
    v_mul_f32 v81, v81, v179
    v_mul_f32 v82, v82, v179
    v_mul_f32 v83, v83, v179
    v_mul_f32 v84, v84, v179
    v_mul_f32 v85, v85, v179
    v_mul_f32 v86, v86, v179
    v_mul_f32 v87, v87, v179
    v_cvt_pk_bf16_f32 v36, v80, v81
    v_cvt_pk_bf16_f32 v37, v82, v83
    v_cvt_pk_bf16_f32 v38, v84, v85
    v_cvt_pk_bf16_f32 v39, v86, v87
    buffer_store_dwordx4 v[32:35], v14, s[12:15], s26 offen sc1
    s_add_u32 s26, s26, 32768
    buffer_store_dwordx4 v[36:39], v14, s[12:15], s26 offen sc1
    s_branch fa_done
fa_early:
    s_waitcnt vmcnt(0)
    s_barrier
    s_cmp_ge_u32 s6, 3
    s_cbranch_scc1 fa_norl
    s_cmp_ge_u32 s2, 192
    s_cbranch_scc1 fa_norl
    s_mul_i32 s52, s2, 3
    s_add_u32 s52, s52, s6
    s_cmp_lt_u32 s52, 128
    s_cselect_b32 s48, s36, s40
    s_cselect_b32 s49, s37, s41
    s_mov_b32 s50, 0x1c0000
    s_cselect_b32 s50, 0x80000, s50
    s_mov_b32 s51, 0x00020000
    s_mov_b32 s53, 128
    s_cselect_b32 s53, 0, s53
    s_mov_b32 s54, 112
    s_cselect_b32 s54, 32, s54
    s_mov_b32 s55, 0x1400000
    s_cselect_b32 s55, 0x1300000, s55
    s_sub_u32 s52, s52, s53
    s_lshr_b32 s53, s52, 4
    s_and_b32 s52, s52, 15
    v_lshrrev_b32 v184, 2, v3
    v_lshlrev_b32 v184, 10, v184
    v_and_b32 v185, 3, v3
    v_lshl_add_u32 v184, v185, 4, v184
    s_lshl_b32 s56, s53, 16
    s_lshl_b32 s57, s52, 6
    s_add_u32 s56, s56, s57
    s_lshl_b32 s57, s6, 12
    s_add_u32 s57, s57, 135168
    s_add_u32 m0, s57, 0
    s_nop 0
    buffer_load_dwordx4 v184, s[48:51], s56 offen lds
    s_add_u32 s56, s56, 16384
    s_add_u32 m0, s57, 1024
    s_nop 0
    buffer_load_dwordx4 v184, s[48:51], s56 offen lds
    s_add_u32 s56, s56, 16384
    s_add_u32 m0, s57, 2048
    s_nop 0
    buffer_load_dwordx4 v184, s[48:51], s56 offen lds
    s_add_u32 s56, s56, 16384
    s_add_u32 m0, s57, 3072
    s_nop 0
    buffer_load_dwordx4 v184, s[48:51], s56 offen lds
    s_add_u32 s56, s56, 16384
    v_lshrrev_b32 v185, 4, v3
    v_and_b32 v186, 3, v3
    v_and_b32 v187, 1, v185
    v_lshl_add_u32 v186, v187, 2, v186
    v_and_b32 v187, 1, v186
    v_lshlrev_b32 v187, 1, v187
    v_bfe_u32 v188, v186, 1, 1
    v_and_b32 v186, 4, v186
    v_or3_b32 v186, v186, v187, v188
    v_lshrrev_b32 v185, 1, v185
    v_bfe_u32 v187, v3, 2, 2
    v_lshl_add_u32 v185, v185, 3, v187
    v_lshlrev_b32 v185, 6, v185
    v_lshl_add_u32 v185, v186, 3, v185
    v_add_u32 v185, s57, v185
    s_mul_i32 s56, s52, s54
    s_lshl_b32 s53, s53, 2
    s_add_u32 s56, s56, s53
    s_lshl_b32 s56, s56, 10
    s_add_u32 s56, s56, s55
    s_waitcnt vmcnt(0)
    ds_read_b64_tr_b16 v[188:189], v185 offset:0
    ds_read_b64_tr_b16 v[190:191], v185 offset:256
    ds_read_b64_tr_b16 v[192:193], v185 offset:1024
    ds_read_b64_tr_b16 v[194:195], v185 offset:1280
    s_waitcnt lgkmcnt(0)
    buffer_store_dwordx4 v[188:191], v14, s[12:15], s56 offen offset:0 sc1
    buffer_store_dwordx4 v[192:195], v14, s[12:15], s56 offen offset:1024 sc1
    s_waitcnt vmcnt(0)
    ds_read_b64_tr_b16 v[188:189], v185 offset:2048
    ds_read_b64_tr_b16 v[190:191], v185 offset:2304
    ds_read_b64_tr_b16 v[192:193], v185 offset:3072
    ds_read_b64_tr_b16 v[194:195], v185 offset:3328
    s_waitcnt lgkmcnt(0)
    buffer_store_dwordx4 v[188:191], v14, s[12:15], s56 offen offset:2048 sc1
    buffer_store_dwordx4 v[192:195], v14, s[12:15], s56 offen offset:3072 sc1
    s_and_b32 s52, s2, 7
    s_lshl_b32 s52, s52, 8
    s_add_u32 s52, s52, 0x1292800
    s_waitcnt vmcnt(0)
    v_mov_b32 v184, 0
    v_mov_b32 v185, 1
    s_mov_b64 exec, 1
    buffer_atomic_add v185, v184, s[12:15], s52 offen
    s_mov_b64 exec, -1
fa_norl:
    s_mov_b32 s47, 0x00020000
    s_mul_i32 s52, s8, 57344
    s_mul_i32 s53, s6, 7168
    s_add_u32 s52, s52, s53
    s_mov_b32 s44, s38
    s_mov_b32 s45, s39
    s_mov_b32 s46, 0x1c0000
    buffer_load_dwordx4 v[188:191], v14, s[44:47], s52 offen
    s_add_u32 s52, s52, 1024
    buffer_load_dwordx4 v[188:191], v14, s[44:47], s52 offen
    s_add_u32 s52, s52, 1024
    buffer_load_dwordx4 v[188:191], v14, s[44:47], s52 offen
    s_add_u32 s52, s52, 1024
    buffer_load_dwordx4 v[188:191], v14, s[44:47], s52 offen
    s_add_u32 s52, s52, 1024
    buffer_load_dwordx4 v[188:191], v14, s[44:47], s52 offen
    s_add_u32 s52, s52, 1024
    buffer_load_dwordx4 v[188:191], v14, s[44:47], s52 offen
    s_add_u32 s52, s52, 1024
    buffer_load_dwordx4 v[188:191], v14, s[44:47], s52 offen
    s_add_u32 s52, s52, 1024
    s_branch fa_cont
fa_done:
    s_setprio 0
    s_lshl_b32 s68, s10, 8
    s_add_u32 s68, s68, 0x1292000
    s_load_dwordx2 s[26:27], s[0:1], 0
    s_load_dwordx2 s[28:29], s[0:1], 80
    s_load_dwordx4 s[60:63], s[0:1], 32
    s_load_dwordx2 s[64:65], s[0:1], 56
    s_load_dwordx2 s[66:67], s[0:1], 64
    v_lshrrev_b32 v2, 6, v0
    v_and_b32 v3, 63, v0
    s_and_b32 s3, s2, 7
    s_lshr_b32 s4, s2, 3
    v_readfirstlane_b32 s6, v2
    s_lshl_b32 s5, s3, 2
    s_and_b32 s9, s4, 3
    s_add_u32 s48, s5, s9
    s_lshr_b32 s49, s4, 2
    s_lshl_b32 s5, s3, 1
    s_and_b32 s9, s4, 1
    s_add_u32 s30, s5, s9
    s_lshr_b32 s31, s4, 1
    v_lshlrev_b32 v1, 4, v3
    s_lshr_b32 s9, s48, 1
    s_lshl_b32 s9, s9, 8
    s_add_u32 s56, s9, 0x1290000
    s_add_u32 s59, s9, 0x1291000
    s_lshl_b32 s9, s30, 8
    s_add_u32 s57, s9, 0x1290000
    s_add_u32 s58, s9, 0x1291000
    s_waitcnt vmcnt(0) lgkmcnt(0)
    s_cmp_lg_u32 s6, 0
    s_cbranch_scc1 m_npw
    v_and_b32 v26, 7, v3
    v_lshlrev_b32 v26, 8, v26
    s_mov_b32 s69, 0x1292800
    s_mov_b32 s55, 0
m_spw:
    buffer_load_dword v29, v26, s[12:15], s69 offen sc1
    s_waitcnt vmcnt(0)
    v_cmp_le_u32 vcc, 72, v29
    s_nop 1
    s_cmp_eq_u64 vcc, -1
    s_cbranch_scc1 m_npw
    s_add_u32 s55, s55, 1
    s_cmp_gt_u32 s55, 200000
    s_cbranch_scc1 m_npw
    s_sleep 4
    s_branch m_spw
m_npw:
    s_barrier
    s_mov_b32 s12, s28
    s_mov_b32 s13, s29
    s_mov_b32 s14, 0x10000000
    s_mov_b32 s15, 0x00020000
    s_cmp_lg_u32 s6, 0
    s_cbranch_scc1 m_nsa
    v_mov_b32 v28, 0
    v_mov_b32 v29, 1
    s_mov_b64 exec, 1
    buffer_atomic_add v29, v28, s[12:15], s68 offen
    s_mov_b64 exec, -1
m_nsa:
    s_cmp_ge_u32 s6, 4
    s_cbranch_scc0 m_comp
    s_sub_u32 s7, s6, 4
    s_waitcnt lgkmcnt(0)
    s_mov_b32 s12, s28
    s_mov_b32 s13, s29
    s_mov_b32 s14, 0x10000000
    s_mov_b32 s15, 0x00020000
    s_cmp_ge_u32 s4, 28
    s_cbranch_scc1 m_lidle
    v_lshrrev_b32 v5, 4, v3
    s_lshl_b32 s8, s7, 2
    v_add_u32 v4, s8, v5
    v_mul_u32_u24 v4, 3584, v4
    v_bfe_u32 v6, v3, 2, 2
    v_xor_b32 v6, v6, v5
    v_and_b32 v7, 3, v3
    v_lshl_add_u32 v6, v6, 2, v7
    v_lshl_add_u32 v2, v6, 4, v4
    s_lshl_b32 s44, s7, 10
    s_lshl_b32 s41, s31, 8
    s_mov_b32 s16, s60
    s_mov_b32 s17, s61
    s_mov_b32 s18, 0x1c0000
    s_mov_b32 s19, 0x00020000
    s_mov_b32 s20, s62
    s_mov_b32 s21, s63
    s_mov_b32 s22, 0xe00
    s_mov_b32 s23, 0x00020000
    s_lshl_b32 s9, s31, 9
    s_add_u32 s9, s9, 0x1280000
    s_lshl_b32 s10, s31, 8
    s_cmp_eq_u32 s7, 1
    s_cbranch_scc1 m_ldb
    s_cmp_eq_u32 s7, 0
    s_mov_b32 s11, 149504
    s_cselect_b32 s11, 147456, s11
    s_mov_b32 m0, s11
    s_nop 0
    buffer_load_dwordx4 v1, s[12:15], s9 offen lds
    s_branch m_ldc
m_ldb:
    s_mov_b32 m0, 148480
    s_nop 0
    buffer_load_dwordx4 v1, s[20:23], s10 offen lds
m_ldc:
    s_mov_b32 m0, s44
    s_add_u32 s44, s44, 4096
    buffer_load_dwordx4 v2, s[16:19], s41 offen lds
    s_add_u32 s41, s41, 57344
    s_mov_b32 m0, s44
    s_add_u32 s44, s44, 4096
    buffer_load_dwordx4 v2, s[16:19], s41 offen lds
    s_add_u32 s41, s41, 57344
    s_mov_b32 m0, s44
    s_add_u32 s44, s44, 4096
    buffer_load_dwordx4 v2, s[16:19], s41 offen lds
    s_add_u32 s41, s41, 57344
    s_mov_b32 m0, s44
    s_add_u32 s44, s44, 4096
    buffer_load_dwordx4 v2, s[16:19], s41 offen lds
    s_add_u32 s41, s41, 57344
    s_mov_b32 m0, s44
    s_add_u32 s44, s44, 4096
    buffer_load_dwordx4 v2, s[16:19], s41 offen lds
    s_add_u32 s41, s41, 57344
    s_mov_b32 m0, s44
    s_add_u32 s44, s44, 4096
    buffer_load_dwordx4 v2, s[16:19], s41 offen lds
    s_add_u32 s41, s41, 57344
    s_mov_b32 m0, s44
    s_add_u32 s44, s44, 4096
    buffer_load_dwordx4 v2, s[16:19], s41 offen lds
    s_add_u32 s41, s41, 57344
    s_mov_b32 m0, s44
    s_add_u32 s44, s44, 4096
    buffer_load_dwordx4 v2, s[16:19], s41 offen lds
    s_add_u32 s41, s41, 57344
    s_mov_b32 m0, s44
    s_add_u32 s44, s44, 4096
    buffer_load_dwordx4 v2, s[16:19], s41 offen lds
    s_add_u32 s41, s41, 57344
    s_mov_b32 m0, s44
    s_add_u32 s44, s44, 4096
    buffer_load_dwordx4 v2, s[16:19], s41 offen lds
    s_add_u32 s41, s41, 57344
    s_mov_b32 m0, s44
    s_add_u32 s44, s44, 4096
    buffer_load_dwordx4 v2, s[16:19], s41 offen lds
    s_add_u32 s41, s41, 57344
    s_mov_b32 m0, s44
    s_add_u32 s44, s44, 4096
    buffer_load_dwordx4 v2, s[16:19], s41 offen lds
    s_add_u32 s41, s41, 57344
    s_mov_b32 m0, s44
    s_add_u32 s44, s44, 4096
    buffer_load_dwordx4 v2, s[16:19], s41 offen lds
    s_add_u32 s41, s41, 57344
    s_mov_b32 m0, s44
    s_add_u32 s44, s44, 4096
    buffer_load_dwordx4 v2, s[16:19], s41 offen lds
    s_add_u32 s41, s41, 57344
    s_mov_b32 m0, s44
    s_add_u32 s44, s44, 4096
    buffer_load_dwordx4 v2, s[16:19], s41 offen lds
    s_add_u32 s41, s41, 57344
    s_mov_b32 m0, s44
    s_add_u32 s44, s44, 4096
    buffer_load_dwordx4 v2, s[16:19], s41 offen lds
    s_add_u32 s41, s41, 57344
    s_mov_b32 m0, s44
    s_add_u32 s44, s44, 4096
    buffer_load_dwordx4 v2, s[16:19], s41 offen lds
    s_add_u32 s41, s41, 57344
    s_mov_b32 m0, s44
    s_add_u32 s44, s44, 4096
    buffer_load_dwordx4 v2, s[16:19], s41 offen lds
    s_add_u32 s41, s41, 57344
    s_mov_b32 m0, s44
    s_add_u32 s44, s44, 4096
    buffer_load_dwordx4 v2, s[16:19], s41 offen lds
    s_add_u32 s41, s41, 57344
    s_mov_b32 m0, s44
    s_add_u32 s44, s44, 4096
    buffer_load_dwordx4 v2, s[16:19], s41 offen lds
    s_add_u32 s41, s41, 57344
    s_barrier
    s_barrier
    s_barrier
    s_mov_b32 m0, s44
    s_add_u32 s44, s44, 4096
    buffer_load_dwordx4 v2, s[16:19], s41 offen lds
    s_add_u32 s41, s41, 57344
    s_mov_b32 m0, s44
    s_add_u32 s44, s44, 4096
    buffer_load_dwordx4 v2, s[16:19], s41 offen lds
    s_add_u32 s41, s41, 57344
    s_mov_b32 m0, s44
    s_add_u32 s44, s44, 4096
    buffer_load_dwordx4 v2, s[16:19], s41 offen lds
    s_add_u32 s41, s41, 57344
    s_mov_b32 m0, s44
    s_add_u32 s44, s44, 4096
    buffer_load_dwordx4 v2, s[16:19], s41 offen lds
    s_add_u32 s41, s41, 57344
    s_mov_b32 m0, s44
    s_add_u32 s44, s44, 4096
    buffer_load_dwordx4 v2, s[16:19], s41 offen lds
    s_add_u32 s41, s41, 57344
    s_mov_b32 m0, s44
    s_add_u32 s44, s44, 4096
    buffer_load_dwordx4 v2, s[16:19], s41 offen lds
    s_add_u32 s41, s41, 57344
    s_mov_b32 m0, s44
    s_add_u32 s44, s44, 4096
    buffer_load_dwordx4 v2, s[16:19], s41 offen lds
    s_add_u32 s41, s41, 57344
    s_mov_b32 m0, s44
    s_add_u32 s44, s44, 4096
    buffer_load_dwordx4 v2, s[16:19], s41 offen lds
    s_add_u32 s41, s41, 57344
    s_mov_b32 m0, s44
    s_add_u32 s44, s44, 4096
    buffer_load_dwordx4 v2, s[16:19], s41 offen lds
    s_add_u32 s41, s41, 57344
    s_mov_b32 m0, s44
    s_add_u32 s44, s44, 4096
    buffer_load_dwordx4 v2, s[16:19], s41 offen lds
    s_add_u32 s41, s41, 57344
    s_mov_b32 m0, s44
    s_add_u32 s44, s44, 4096
    buffer_load_dwordx4 v2, s[16:19], s41 offen lds
    s_add_u32 s41, s41, 57344
    s_mov_b32 m0, s44
    s_add_u32 s44, s44, 4096
    buffer_load_dwordx4 v2, s[16:19], s41 offen lds
    s_add_u32 s41, s41, 57344
    s_waitcnt vmcnt(12)
    s_barrier
    s_lshl_b32 s9, s30, 10
    s_lshl_b32 s10, s7, 16
    s_add_u32 s9, s9, s10
    s_add_u32 s9, s9, 0x1200000
    buffer_load_dwordx4 v[8:11], v1, s[12:15], s9 offen sc1
    s_add_u32 s9, s9, 16384
    buffer_load_dwordx4 v[12:15], v1, s[12:15], s9 offen sc1
    s_add_u32 s9, s9, 16384
    buffer_load_dwordx4 v[16:19], v1, s[12:15], s9 offen sc1
    s_add_u32 s9, s9, 16384
    buffer_load_dwordx4 v[20:23], v1, s[12:15], s9 offen sc1
    s_add_u32 s9, s9, 16384
    s_lshl_b32 s10, s7, 12
    s_add_u32 s10, s10, 131072
    v_add_u32 v4, s10, v1
    s_waitcnt vmcnt(0)
    ds_write_b128 v4, v[8:11] offset:0
    ds_write_b128 v4, v[12:15] offset:1024
    ds_write_b128 v4, v[16:19] offset:2048
    ds_write_b128 v4, v[20:23] offset:3072
    s_waitcnt lgkmcnt(0)
    s_barrier
    s_lshl_b32 s9, s4, 2
    s_add_u32 s9, s9, s7
    s_lshl_b32 s9, s9, 13
    s_add_u32 s9, s9, 0x14e0000
    buffer_load_dwordx4 v[8:11], v1, s[12:15], s9 offen offset:0
    buffer_load_dwordx4 v[8:11], v1, s[12:15], s9 offen offset:1024
    buffer_load_dwordx4 v[8:11], v1, s[12:15], s9 offen offset:2048
    buffer_load_dwordx4 v[8:11], v1, s[12:15], s9 offen offset:3072
    s_add_u32 s9, s9, 4096
    buffer_load_dwordx4 v[8:11], v1, s[12:15], s9 offen offset:0
    buffer_load_dwordx4 v[8:11], v1, s[12:15], s9 offen offset:1024
    buffer_load_dwordx4 v[8:11], v1, s[12:15], s9 offen offset:2048
    buffer_load_dwordx4 v[8:11], v1, s[12:15], s9 offen offset:3072
    s_endpgm
m_lidle:
    s_barrier
    s_barrier
    s_barrier
    s_sub_u32 s9, s4, 28
    s_lshl_b32 s9, s9, 2
    s_add_u32 s9, s9, s7
    s_mul_i32 s9, s9, 57344
    s_add_u32 s9, s9, 0x1400000
    s_mov_b32 s10, 14
m_pf:
    buffer_load_dwordx4 v[8:11], v1, s[12:15], s9 offen offset:0
    buffer_load_dwordx4 v[8:11], v1, s[12:15], s9 offen offset:1024
    buffer_load_dwordx4 v[8:11], v1, s[12:15], s9 offen offset:2048
    buffer_load_dwordx4 v[8:11], v1, s[12:15], s9 offen offset:3072
    s_add_u32 s9, s9, 4096
    s_waitcnt vmcnt(16)
    s_sub_u32 s10, s10, 1
    s_cmp_lg_u32 s10, 0
    s_cbranch_scc1 m_pf
    s_endpgm
m_comp:
    s_lshr_b32 s7, s6, 1
    s_and_b32 s8, s6, 1
    v_and_b32 v4, 31, v3
    v_lshrrev_b32 v5, 5, v3
    s_lshl_b32 s9, s48, 1
    s_add_u32 s50, s9, s7
    s_xor_b32 s10, s50, 1
    s_mul_i32 s11, s6, 8
    s_mul_i32 s40, s50, 32
    s_add_u32 s40, s40, s11
    s_lshl_b32 s40, s40, 10
    s_add_u32 s40, s40, 0x600000
    s_mul_i32 s41, s10, 32
    s_add_u32 s41, s41, s11
    s_lshl_b32 s41, s41, 10
    s_add_u32 s41, s41, 0x600000
    s_lshl_b32 s9, s49, 1
    s_add_u32 s9, s9, s8
    s_xor_b32 s10, s9, 1
    s_mul_i32 s42, s9, 32
    s_add_u32 s42, s42, s11
    s_lshl_b32 s42, s42, 10
    s_add_u32 s42, s42, 0x1300000
    s_mul_i32 s43, s10, 32
    s_add_u32 s43, s43, s11
    s_lshl_b32 s43, s43, 10
    s_add_u32 s43, s43, 0x1300000
    s_lshl_b32 s51, s9, 1
    s_waitcnt lgkmcnt(0)
    s_mov_b32 s12, s28
    s_mov_b32 s13, s29
    s_mov_b32 s14, 0x10000000
    s_mov_b32 s15, 0x00020000
    v_lshlrev_b32 v6, 10, v4
    v_lshl_add_u32 v6, v5, 4, v6
    s_lshl_b32 s52, s50, 15
    s_lshl_b32 s9, s51, 5
    s_add_u32 s52, s52, s9
    s_lshl_b32 s53, s50, 5
    s_add_u32 s53, s53, s51
    s_lshl_b32 s53, s53, 10
    s_add_u32 s53, s53, 0x800000
    buffer_load_dwordx4 v[72:75], v1, s[12:15], s42 offen offset:0 sc1
    buffer_load_dwordx4 v[76:79], v1, s[12:15], s43 offen offset:0 sc1
    buffer_load_dwordx4 v[88:91], v1, s[12:15], s42 offen offset:1024 sc1
    buffer_load_dwordx4 v[92:95], v1, s[12:15], s43 offen offset:1024 sc1
    buffer_load_dwordx4 v[104:107], v1, s[12:15], s42 offen offset:2048 sc1
    buffer_load_dwordx4 v[108:111], v1, s[12:15], s43 offen offset:2048 sc1
    buffer_load_dwordx4 v[120:123], v1, s[12:15], s42 offen offset:3072 sc1
    buffer_load_dwordx4 v[124:127], v1, s[12:15], s43 offen offset:3072 sc1
    s_add_u32 s42, s42, 4096
    s_add_u32 s43, s43, 4096
    buffer_load_dwordx4 v[136:139], v1, s[12:15], s42 offen offset:0 sc1
    buffer_load_dwordx4 v[140:143], v1, s[12:15], s43 offen offset:0 sc1
    buffer_load_dwordx4 v[152:155], v1, s[12:15], s42 offen offset:1024 sc1
    buffer_load_dwordx4 v[156:159], v1, s[12:15], s43 offen offset:1024 sc1
    buffer_load_dwordx4 v[168:171], v1, s[12:15], s42 offen offset:2048 sc1
    buffer_load_dwordx4 v[172:175], v1, s[12:15], s43 offen offset:2048 sc1
    buffer_load_dwordx4 v[184:187], v1, s[12:15], s42 offen offset:3072 sc1
    buffer_load_dwordx4 v[188:191], v1, s[12:15], s43 offen offset:3072 sc1
    s_mov_b32 s32, s26
    s_mov_b32 s33, s27
    s_mov_b32 s34, 0x200000
    s_mov_b32 s35, 0x00020000
    buffer_load_dwordx4 v[32:35], v6, s[32:35], s52 offen
    buffer_load_dwordx4 v[36:39], v6, s[32:35], s52 offen offset:32
    s_cmp_lg_u32 s6, 0
    s_cbranch_scc1 m_np3
    s_lshl_b32 s69, s3, 8
    s_add_u32 s69, s69, 0x1292000
    v_mov_b32 v28, 0
    s_mov_b32 s55, 0
m_sp2:
    buffer_load_dword v29, v28, s[12:15], s69 offen sc1
    s_waitcnt vmcnt(0)
    v_readfirstlane_b32 s54, v29
    s_cmp_ge_u32 s54, 32
    s_cbranch_scc1 m_sp2d
    s_add_u32 s55, s55, 1
    s_cmp_gt_u32 s55, 200000
    s_cbranch_scc1 m_sp2d
    s_sleep 4
    s_branch m_sp2
m_sp2d:
m_np3:
    s_barrier
    buffer_load_dwordx4 v[64:67], v1, s[12:15], s40 offen offset:0 sc1
    buffer_load_dwordx4 v[68:71], v1, s[12:15], s41 offen offset:0 sc1
    buffer_load_dwordx4 v[80:83], v1, s[12:15], s40 offen offset:1024 sc1
    buffer_load_dwordx4 v[84:87], v1, s[12:15], s41 offen offset:1024 sc1
    buffer_load_dwordx4 v[96:99], v1, s[12:15], s40 offen offset:2048 sc1
    buffer_load_dwordx4 v[100:103], v1, s[12:15], s41 offen offset:2048 sc1
    buffer_load_dwordx4 v[112:115], v1, s[12:15], s40 offen offset:3072 sc1
    buffer_load_dwordx4 v[116:119], v1, s[12:15], s41 offen offset:3072 sc1
    s_add_u32 s40, s40, 4096
    s_add_u32 s41, s41, 4096
    buffer_load_dwordx4 v[128:131], v1, s[12:15], s40 offen offset:0 sc1
    buffer_load_dwordx4 v[132:135], v1, s[12:15], s41 offen offset:0 sc1
    buffer_load_dwordx4 v[144:147], v1, s[12:15], s40 offen offset:1024 sc1
    buffer_load_dwordx4 v[148:151], v1, s[12:15], s41 offen offset:1024 sc1
    buffer_load_dwordx4 v[160:163], v1, s[12:15], s40 offen offset:2048 sc1
    buffer_load_dwordx4 v[164:167], v1, s[12:15], s41 offen offset:2048 sc1
    buffer_load_dwordx4 v[176:179], v1, s[12:15], s40 offen offset:3072 sc1
    buffer_load_dwordx4 v[180:183], v1, s[12:15], s41 offen offset:3072 sc1
    s_waitcnt vmcnt(14)
    v_mfma_f32_32x32x16_bf16 v[192:207], v[72:75], v[64:67], 0
    v_mfma_f32_32x32x16_bf16 v[208:223], v[72:75], v[68:71], 0
    v_mfma_f32_32x32x16_bf16 v[224:239], v[76:79], v[64:67], 0
    v_mfma_f32_32x32x16_bf16 v[240:255], v[76:79], v[68:71], 0
    s_waitcnt vmcnt(12)
    v_mfma_f32_32x32x16_bf16 v[192:207], v[88:91], v[80:83], v[192:207]
    v_mfma_f32_32x32x16_bf16 v[208:223], v[88:91], v[84:87], v[208:223]
    v_mfma_f32_32x32x16_bf16 v[224:239], v[92:95], v[80:83], v[224:239]
    v_mfma_f32_32x32x16_bf16 v[240:255], v[92:95], v[84:87], v[240:255]
    s_waitcnt vmcnt(10)
    v_mfma_f32_32x32x16_bf16 v[192:207], v[104:107], v[96:99], v[192:207]
    v_mfma_f32_32x32x16_bf16 v[208:223], v[104:107], v[100:103], v[208:223]
    v_mfma_f32_32x32x16_bf16 v[224:239], v[108:111], v[96:99], v[224:239]
    v_mfma_f32_32x32x16_bf16 v[240:255], v[108:111], v[100:103], v[240:255]
    s_waitcnt vmcnt(8)
    v_mfma_f32_32x32x16_bf16 v[192:207], v[120:123], v[112:115], v[192:207]
    v_mfma_f32_32x32x16_bf16 v[208:223], v[120:123], v[116:119], v[208:223]
    v_mfma_f32_32x32x16_bf16 v[224:239], v[124:127], v[112:115], v[224:239]
    v_mfma_f32_32x32x16_bf16 v[240:255], v[124:127], v[116:119], v[240:255]
    s_waitcnt vmcnt(6)
    v_mfma_f32_32x32x16_bf16 v[192:207], v[136:139], v[128:131], v[192:207]
    v_mfma_f32_32x32x16_bf16 v[208:223], v[136:139], v[132:135], v[208:223]
    v_mfma_f32_32x32x16_bf16 v[224:239], v[140:143], v[128:131], v[224:239]
    v_mfma_f32_32x32x16_bf16 v[240:255], v[140:143], v[132:135], v[240:255]
    s_waitcnt vmcnt(4)
    v_mfma_f32_32x32x16_bf16 v[192:207], v[152:155], v[144:147], v[192:207]
    v_mfma_f32_32x32x16_bf16 v[208:223], v[152:155], v[148:151], v[208:223]
    v_mfma_f32_32x32x16_bf16 v[224:239], v[156:159], v[144:147], v[224:239]
    v_mfma_f32_32x32x16_bf16 v[240:255], v[156:159], v[148:151], v[240:255]
    s_waitcnt vmcnt(2)
    v_mfma_f32_32x32x16_bf16 v[192:207], v[168:171], v[160:163], v[192:207]
    v_mfma_f32_32x32x16_bf16 v[208:223], v[168:171], v[164:167], v[208:223]
    v_mfma_f32_32x32x16_bf16 v[224:239], v[172:175], v[160:163], v[224:239]
    v_mfma_f32_32x32x16_bf16 v[240:255], v[172:175], v[164:167], v[240:255]
    s_waitcnt vmcnt(0)
    v_mfma_f32_32x32x16_bf16 v[192:207], v[184:187], v[176:179], v[192:207]
    v_mfma_f32_32x32x16_bf16 v[208:223], v[184:187], v[180:183], v[208:223]
    v_mfma_f32_32x32x16_bf16 v[224:239], v[188:191], v[176:179], v[224:239]
    v_mfma_f32_32x32x16_bf16 v[240:255], v[188:191], v[180:183], v[240:255]
    s_nop 7
    s_xor_b32 s9, s6, 1
    s_mul_i32 s9, s9, 3
    s_add_u32 s9, s9, 0
    s_lshl_b32 s9, s9, 12
    s_add_u32 s9, s9, 81920
    v_add_u32 v9, s9, v1
    s_xor_b32 s9, s6, 2
    s_mul_i32 s9, s9, 3
    s_add_u32 s9, s9, 1
    s_lshl_b32 s9, s9, 12
    s_add_u32 s9, s9, 81920
    v_add_u32 v10, s9, v1
    s_xor_b32 s9, s6, 3
    s_mul_i32 s9, s9, 3
    s_add_u32 s9, s9, 2
    s_lshl_b32 s9, s9, 12
    s_add_u32 s9, s9, 81920
    v_add_u32 v11, s9, v1
    ds_write_b128 v9, v[224:227] offset:0
    ds_write_b128 v9, v[228:231] offset:1024
    ds_write_b128 v9, v[232:235] offset:2048
    ds_write_b128 v9, v[236:239] offset:3072
    ds_write_b128 v10, v[208:211] offset:0
    ds_write_b128 v10, v[212:215] offset:1024
    ds_write_b128 v10, v[216:219] offset:2048
    ds_write_b128 v10, v[220:223] offset:3072
    ds_write_b128 v11, v[240:243] offset:0
    ds_write_b128 v11, v[244:247] offset:1024
    ds_write_b128 v11, v[248:251] offset:2048
    ds_write_b128 v11, v[252:255] offset:3072
    s_mul_i32 s9, s6, 12288
    s_add_u32 s9, s9, 81920
    v_add_u32 v8, s9, v1
    s_waitcnt vmcnt(0)
    v_lshlrev_b32 v112, 16, v32
    v_and_b32 v113, 0xffff0000, v32
    v_lshlrev_b32 v114, 16, v33
    v_and_b32 v115, 0xffff0000, v33
    v_lshlrev_b32 v116, 16, v34
    v_and_b32 v117, 0xffff0000, v34
    v_lshlrev_b32 v118, 16, v35
    v_and_b32 v119, 0xffff0000, v35
    v_lshlrev_b32 v120, 16, v36
    v_and_b32 v121, 0xffff0000, v36
    v_lshlrev_b32 v122, 16, v37
    v_and_b32 v123, 0xffff0000, v37
    v_lshlrev_b32 v124, 16, v38
    v_and_b32 v125, 0xffff0000, v38
    v_lshlrev_b32 v126, 16, v39
    v_and_b32 v127, 0xffff0000, v39
    v_pk_add_f32 v[192:193], v[192:193], v[112:113]
    v_pk_add_f32 v[194:195], v[194:195], v[114:115]
    v_pk_add_f32 v[196:197], v[196:197], v[116:117]
    v_pk_add_f32 v[198:199], v[198:199], v[118:119]
    v_pk_add_f32 v[200:201], v[200:201], v[120:121]
    v_pk_add_f32 v[202:203], v[202:203], v[122:123]
    v_pk_add_f32 v[204:205], v[204:205], v[124:125]
    v_pk_add_f32 v[206:207], v[206:207], v[126:127]
    s_waitcnt lgkmcnt(0)
    s_barrier
    ds_read_b128 v[64:67], v8 offset:0
    ds_read_b128 v[68:71], v8 offset:1024
    ds_read_b128 v[72:75], v8 offset:2048
    ds_read_b128 v[76:79], v8 offset:3072
    ds_read_b128 v[80:83], v8 offset:4096
    ds_read_b128 v[84:87], v8 offset:5120
    ds_read_b128 v[88:91], v8 offset:6144
    ds_read_b128 v[92:95], v8 offset:7168
    ds_read_b128 v[96:99], v8 offset:8192
    ds_read_b128 v[100:103], v8 offset:9216
    ds_read_b128 v[104:107], v8 offset:10240
    ds_read_b128 v[108:111], v8 offset:11264
    s_waitcnt lgkmcnt(8)
    v_pk_add_f32 v[192:193], v[192:193], v[64:65]
    v_pk_add_f32 v[194:195], v[194:195], v[66:67]
    v_pk_add_f32 v[196:197], v[196:197], v[68:69]
    v_pk_add_f32 v[198:199], v[198:199], v[70:71]
    v_pk_add_f32 v[200:201], v[200:201], v[72:73]
    v_pk_add_f32 v[202:203], v[202:203], v[74:75]
    v_pk_add_f32 v[204:205], v[204:205], v[76:77]
    v_pk_add_f32 v[206:207], v[206:207], v[78:79]
    s_waitcnt lgkmcnt(4)
    v_pk_add_f32 v[192:193], v[192:193], v[80:81]
    v_pk_add_f32 v[194:195], v[194:195], v[82:83]
    v_pk_add_f32 v[196:197], v[196:197], v[84:85]
    v_pk_add_f32 v[198:199], v[198:199], v[86:87]
    v_pk_add_f32 v[200:201], v[200:201], v[88:89]
    v_pk_add_f32 v[202:203], v[202:203], v[90:91]
    v_pk_add_f32 v[204:205], v[204:205], v[92:93]
    v_pk_add_f32 v[206:207], v[206:207], v[94:95]
    s_waitcnt lgkmcnt(0)
    v_pk_add_f32 v[192:193], v[192:193], v[96:97]
    v_pk_add_f32 v[194:195], v[194:195], v[98:99]
    v_pk_add_f32 v[196:197], v[196:197], v[100:101]
    v_pk_add_f32 v[198:199], v[198:199], v[102:103]
    v_pk_add_f32 v[200:201], v[200:201], v[104:105]
    v_pk_add_f32 v[202:203], v[202:203], v[106:107]
    v_pk_add_f32 v[204:205], v[204:205], v[108:109]
    v_pk_add_f32 v[206:207], v[206:207], v[110:111]
    v_cvt_pk_bf16_f32 v240, v192, v193
    v_cvt_pk_bf16_f32 v241, v194, v195
    v_cvt_pk_bf16_f32 v242, v196, v197
    v_cvt_pk_bf16_f32 v243, v198, v199
    v_cvt_pk_bf16_f32 v244, v200, v201
    v_cvt_pk_bf16_f32 v245, v202, v203
    v_cvt_pk_bf16_f32 v246, v204, v205
    v_cvt_pk_bf16_f32 v247, v206, v207
    buffer_store_dwordx4 v[240:243], v1, s[12:15], s53 offen sc1
    buffer_store_dwordx4 v[244:247], v1, s[12:15], s53 offen offset:1024 sc1
    v_mov_b32 v20, 0
    v_mov_b32 v21, 0
    v_mov_b32 v22, 0
    v_mov_b32 v23, 0
    v_lshlrev_b32 v24, 16, v240
    v_and_b32 v25, 0xffff0000, v240
    v_add_f32 v20, v20, v24
    v_add_f32 v22, v22, v25
    v_fmac_f32 v21, v24, v24
    v_fmac_f32 v23, v25, v25
    v_lshlrev_b32 v26, 16, v241
    v_and_b32 v27, 0xffff0000, v241
    v_add_f32 v20, v20, v26
    v_add_f32 v22, v22, v27
    v_fmac_f32 v21, v26, v26
    v_fmac_f32 v23, v27, v27
    v_lshlrev_b32 v24, 16, v242
    v_and_b32 v25, 0xffff0000, v242
    v_add_f32 v20, v20, v24
    v_add_f32 v22, v22, v25
    v_fmac_f32 v21, v24, v24
    v_fmac_f32 v23, v25, v25
    v_lshlrev_b32 v26, 16, v243
    v_and_b32 v27, 0xffff0000, v243
    v_add_f32 v20, v20, v26
    v_add_f32 v22, v22, v27
    v_fmac_f32 v21, v26, v26
    v_fmac_f32 v23, v27, v27
    v_lshlrev_b32 v24, 16, v244
    v_and_b32 v25, 0xffff0000, v244
    v_add_f32 v20, v20, v24
    v_add_f32 v22, v22, v25
    v_fmac_f32 v21, v24, v24
    v_fmac_f32 v23, v25, v25
    v_lshlrev_b32 v26, 16, v245
    v_and_b32 v27, 0xffff0000, v245
    v_add_f32 v20, v20, v26
    v_add_f32 v22, v22, v27
    v_fmac_f32 v21, v26, v26
    v_fmac_f32 v23, v27, v27
    v_lshlrev_b32 v24, 16, v246
    v_and_b32 v25, 0xffff0000, v246
    v_add_f32 v20, v20, v24
    v_add_f32 v22, v22, v25
    v_fmac_f32 v21, v24, v24
    v_fmac_f32 v23, v25, v25
    v_lshlrev_b32 v26, 16, v247
    v_and_b32 v27, 0xffff0000, v247
    v_add_f32 v20, v20, v26
    v_add_f32 v22, v22, v27
    v_fmac_f32 v21, v26, v26
    v_fmac_f32 v23, v27, v27
    v_add_f32 v20, v20, v22
    v_add_f32 v21, v21, v23
    v_mov_b32 v22, v20
    v_mov_b32 v23, v21
    s_nop 1
    v_permlane32_swap_b32 v20, v22
    v_permlane32_swap_b32 v21, v23
    s_nop 1
    v_add_f32 v20, v20, v22
    v_add_f32 v21, v21, v23
    v_lshlrev_b32 v2, 3, v4
    s_lshl_b32 s9, s50, 8
    s_lshl_b32 s10, s51, 13
    s_add_u32 s9, s9, s10
    s_add_u32 s9, s9, 0x1200000
    buffer_store_dwordx2 v[20:21], v2, s[12:15], s9 offen sc1
    s_waitcnt vmcnt(0)
    s_barrier
    s_cmp_lg_u32 s6, 0
    s_cbranch_scc1 m_ns3
    v_mov_b32 v28, 0
    v_mov_b32 v29, 1
    s_mov_b64 exec, 1
    buffer_atomic_add v29, v28, s[12:15], s56 offen
    s_mov_b64 exec, -1
m_ns3:
    s_cmp_ge_u32 s4, 28
    s_cbranch_scc1 m_p5
    s_lshl_b32 s9, s30, 2
    s_add_u32 s9, s9, s6
    s_mov_b32 s33, s9
    s_lshl_b32 s34, s9, 15
    s_add_u32 s34, s34, 0x800000
    v_lshrrev_b32 v6, 4, v3
    v_bfe_u32 v7, v3, 2, 2
    v_and_b32 v18, 3, v3
    v_and_b32 v19, 1, v6
    v_lshl_add_u32 v18, v19, 2, v18
    v_and_b32 v19, 1, v18
    v_lshlrev_b32 v19, 1, v19
    v_bfe_u32 v20, v18, 1, 1
    v_and_b32 v18, 4, v18
    v_or3_b32 v18, v18, v19, v20
    v_lshrrev_b32 v6, 1, v6
    v_lshl_add_u32 v6, v6, 3, v7
    v_lshlrev_b32 v6, 8, v6
    v_lshl_add_u32 v6, v18, 3, v6
    v_xor_b32 v19, 0, v7
    v_lshl_add_u32 v8, v19, 6, v6
    v_xor_b32 v19, 1, v7
    v_lshl_add_u32 v9, v19, 6, v6
    v_xor_b32 v19, 2, v7
    v_lshl_add_u32 v10, v19, 6, v6
    v_xor_b32 v19, 3, v7
    v_lshl_add_u32 v11, v19, 6, v6
    v_mov_b32 v176, 0
    v_mov_b32 v177, 0
    v_mov_b32 v178, 0
    v_mov_b32 v179, 0
    v_mov_b32 v180, 0
    v_mov_b32 v181, 0
    v_mov_b32 v182, 0
    v_mov_b32 v183, 0
    v_mov_b32 v184, 0
    v_mov_b32 v185, 0
    v_mov_b32 v186, 0
    v_mov_b32 v187, 0
    v_mov_b32 v188, 0
    v_mov_b32 v189, 0
    v_mov_b32 v190, 0
    v_mov_b32 v191, 0
    v_mov_b32 v192, 0
    v_mov_b32 v193, 0
    v_mov_b32 v194, 0
    v_mov_b32 v195, 0
    v_mov_b32 v196, 0
    v_mov_b32 v197, 0
    v_mov_b32 v198, 0
    v_mov_b32 v199, 0
    v_mov_b32 v200, 0
    v_mov_b32 v201, 0
    v_mov_b32 v202, 0
    v_mov_b32 v203, 0
    v_mov_b32 v204, 0
    v_mov_b32 v205, 0
    v_mov_b32 v206, 0
    v_mov_b32 v207, 0
    v_mov_b32 v208, 0
    v_mov_b32 v209, 0
    v_mov_b32 v210, 0
    v_mov_b32 v211, 0
    v_mov_b32 v212, 0
    v_mov_b32 v213, 0
    v_mov_b32 v214, 0
    v_mov_b32 v215, 0
    v_mov_b32 v216, 0
    v_mov_b32 v217, 0
    v_mov_b32 v218, 0
    v_mov_b32 v219, 0
    v_mov_b32 v220, 0
    v_mov_b32 v221, 0
    v_mov_b32 v222, 0
    v_mov_b32 v223, 0
    v_mov_b32 v224, 0
    v_mov_b32 v225, 0
    v_mov_b32 v226, 0
    v_mov_b32 v227, 0
    v_mov_b32 v228, 0
    v_mov_b32 v229, 0
    v_mov_b32 v230, 0
    v_mov_b32 v231, 0
    v_mov_b32 v232, 0
    v_mov_b32 v233, 0
    v_mov_b32 v234, 0
    v_mov_b32 v235, 0
    v_mov_b32 v236, 0
    v_mov_b32 v237, 0
    v_mov_b32 v238, 0
    v_mov_b32 v239, 0
    s_lshl_b32 s9, s6, 5
    v_add_u32 v14, s9, v4
    v_lshlrev_b32 v14, 3, v14
    v_lshl_add_u32 v14, v5, 13, v14
    v_add_u32 v14, 131072, v14
    v_lshlrev_b32 v15, 5, v5
    v_add_u32 v15, 147456, v15
    v_lshlrev_b32 v16, 4, v5
    v_add_u32 v16, 148480, v16
    v_mov_b32 v17, 0xffff0000
    s_cmp_lg_u32 s6, 0
    s_cbranch_scc1 m_np4
    v_mov_b32 v28, 0
    s_mov_b32 s55, 0
m_sp3:
    buffer_load_dword v29, v28, s[12:15], s57 offen sc1
    s_waitcnt vmcnt(0)
    v_readfirstlane_b32 s54, v29
    s_cmp_ge_u32 s54, 16
    s_cbranch_scc1 m_sp3d
    s_add_u32 s55, s55, 1
    s_cmp_gt_u32 s55, 200000
    s_cbranch_scc1 m_sp3d
    s_sleep 4
    s_branch m_sp3
m_sp3d:
m_np4:
    s_barrier
    buffer_load_dwordx4 v[32:35], v1, s[12:15], s34 offen offset:0 sc1
    buffer_load_dwordx4 v[36:39], v1, s[12:15], s34 offen offset:1024 sc1
    buffer_load_dwordx4 v[40:43], v1, s[12:15], s34 offen offset:2048 sc1
    buffer_load_dwordx4 v[44:47], v1, s[12:15], s34 offen offset:3072 sc1
    s_add_u32 s34, s34, 4096
    buffer_load_dwordx4 v[48:51], v1, s[12:15], s34 offen offset:0 sc1
    buffer_load_dwordx4 v[52:55], v1, s[12:15], s34 offen offset:1024 sc1
    buffer_load_dwordx4 v[56:59], v1, s[12:15], s34 offen offset:2048 sc1
    buffer_load_dwordx4 v[60:63], v1, s[12:15], s34 offen offset:3072 sc1
    s_add_u32 s34, s34, 4096
    buffer_load_dwordx4 v[64:67], v1, s[12:15], s34 offen offset:0 sc1
    buffer_load_dwordx4 v[68:71], v1, s[12:15], s34 offen offset:1024 sc1
    buffer_load_dwordx4 v[72:75], v1, s[12:15], s34 offen offset:2048 sc1
    buffer_load_dwordx4 v[76:79], v1, s[12:15], s34 offen offset:3072 sc1
    ds_read_b64_tr_b16 v[160:161], v8 offset:0
    ds_read_b64_tr_b16 v[162:163], v8 offset:1024
    ds_read_b64_tr_b16 v[164:165], v9 offset:0
    ds_read_b64_tr_b16 v[166:167], v9 offset:1024
    ds_read_b64_tr_b16 v[168:169], v10 offset:0
    ds_read_b64_tr_b16 v[170:171], v10 offset:1024
    ds_read_b64_tr_b16 v[172:173], v11 offset:0
    ds_read_b64_tr_b16 v[174:175], v11 offset:1024
    s_waitcnt vmcnt(11)
    s_waitcnt lgkmcnt(6)
    v_mfma_f32_32x32x16_bf16 v[176:191], v[160:163], v[32:35], v[176:191]
    ds_read_b64_tr_b16 v[160:161], v8 offset:4096
    ds_read_b64_tr_b16 v[162:163], v8 offset:5120
    s_add_u32 s34, s34, 4096
    buffer_load_dwordx4 v[80:83], v1, s[12:15], s34 offen offset:0 sc1
    s_waitcnt lgkmcnt(6)
    v_mfma_f32_32x32x16_bf16 v[192:207], v[164:167], v[32:35], v[192:207]
    ds_read_b64_tr_b16 v[164:165], v9 offset:4096
    ds_read_b64_tr_b16 v[166:167], v9 offset:5120
    s_waitcnt lgkmcnt(6)
    v_mfma_f32_32x32x16_bf16 v[208:223], v[168:171], v[32:35], v[208:223]
    ds_read_b64_tr_b16 v[168:169], v10 offset:4096
    ds_read_b64_tr_b16 v[170:171], v10 offset:5120
    s_waitcnt lgkmcnt(6)
    v_mfma_f32_32x32x16_bf16 v[224:239], v[172:175], v[32:35], v[224:239]
    ds_read_b64_tr_b16 v[172:173], v11 offset:4096
    ds_read_b64_tr_b16 v[174:175], v11 offset:5120
    s_waitcnt vmcnt(11)
    s_waitcnt lgkmcnt(6)
    v_mfma_f32_32x32x16_bf16 v[176:191], v[160:163], v[36:39], v[176:191]
    ds_read_b64_tr_b16 v[160:161], v8 offset:8192
    ds_read_b64_tr_b16 v[162:163], v8 offset:9216
    buffer_load_dwordx4 v[84:87], v1, s[12:15], s34 offen offset:1024 sc1
    s_waitcnt lgkmcnt(6)
    v_mfma_f32_32x32x16_bf16 v[192:207], v[164:167], v[36:39], v[192:207]
    ds_read_b64_tr_b16 v[164:165], v9 offset:8192
    ds_read_b64_tr_b16 v[166:167], v9 offset:9216
    s_waitcnt lgkmcnt(6)
    v_mfma_f32_32x32x16_bf16 v[208:223], v[168:171], v[36:39], v[208:223]
    ds_read_b64_tr_b16 v[168:169], v10 offset:8192
    ds_read_b64_tr_b16 v[170:171], v10 offset:9216
    s_waitcnt lgkmcnt(6)
    v_mfma_f32_32x32x16_bf16 v[224:239], v[172:175], v[36:39], v[224:239]
    ds_read_b64_tr_b16 v[172:173], v11 offset:8192
    ds_read_b64_tr_b16 v[174:175], v11 offset:9216
    s_waitcnt vmcnt(11)
    s_waitcnt lgkmcnt(6)
    v_mfma_f32_32x32x16_bf16 v[176:191], v[160:163], v[40:43], v[176:191]
    ds_read_b64_tr_b16 v[160:161], v8 offset:12288
    ds_read_b64_tr_b16 v[162:163], v8 offset:13312
    buffer_load_dwordx4 v[88:91], v1, s[12:15], s34 offen offset:2048 sc1
    s_waitcnt lgkmcnt(6)
    v_mfma_f32_32x32x16_bf16 v[192:207], v[164:167], v[40:43], v[192:207]
    ds_read_b64_tr_b16 v[164:165], v9 offset:12288
    ds_read_b64_tr_b16 v[166:167], v9 offset:13312
    s_waitcnt lgkmcnt(6)
    v_mfma_f32_32x32x16_bf16 v[208:223], v[168:171], v[40:43], v[208:223]
    ds_read_b64_tr_b16 v[168:169], v10 offset:12288
    ds_read_b64_tr_b16 v[170:171], v10 offset:13312
    s_waitcnt lgkmcnt(6)
    v_mfma_f32_32x32x16_bf16 v[224:239], v[172:175], v[40:43], v[224:239]
    ds_read_b64_tr_b16 v[172:173], v11 offset:12288
    ds_read_b64_tr_b16 v[174:175], v11 offset:13312
    v_add_u32 v8, 16384, v8
    v_add_u32 v9, 16384, v9
    v_add_u32 v10, 16384, v10
    v_add_u32 v11, 16384, v11
    s_waitcnt vmcnt(11)
    s_waitcnt lgkmcnt(6)
    v_mfma_f32_32x32x16_bf16 v[176:191], v[160:163], v[44:47], v[176:191]
    ds_read_b64_tr_b16 v[160:161], v8 offset:0
    ds_read_b64_tr_b16 v[162:163], v8 offset:1024
    buffer_load_dwordx4 v[92:95], v1, s[12:15], s34 offen offset:3072 sc1
    s_waitcnt lgkmcnt(6)
    v_mfma_f32_32x32x16_bf16 v[192:207], v[164:167], v[44:47], v[192:207]
    ds_read_b64_tr_b16 v[164:165], v9 offset:0
    ds_read_b64_tr_b16 v[166:167], v9 offset:1024
    s_waitcnt lgkmcnt(6)
    v_mfma_f32_32x32x16_bf16 v[208:223], v[168:171], v[44:47], v[208:223]
    ds_read_b64_tr_b16 v[168:169], v10 offset:0
    ds_read_b64_tr_b16 v[170:171], v10 offset:1024
    s_waitcnt lgkmcnt(6)
    v_mfma_f32_32x32x16_bf16 v[224:239], v[172:175], v[44:47], v[224:239]
    ds_read_b64_tr_b16 v[172:173], v11 offset:0
    ds_read_b64_tr_b16 v[174:175], v11 offset:1024
    s_waitcnt vmcnt(11)
    s_waitcnt lgkmcnt(6)
    v_mfma_f32_32x32x16_bf16 v[176:191], v[160:163], v[48:51], v[176:191]
    ds_read_b64_tr_b16 v[160:161], v8 offset:4096
    ds_read_b64_tr_b16 v[162:163], v8 offset:5120
    s_add_u32 s34, s34, 4096
    buffer_load_dwordx4 v[96:99], v1, s[12:15], s34 offen offset:0 sc1
    s_waitcnt lgkmcnt(6)
    v_mfma_f32_32x32x16_bf16 v[192:207], v[164:167], v[48:51], v[192:207]
    ds_read_b64_tr_b16 v[164:165], v9 offset:4096
    ds_read_b64_tr_b16 v[166:167], v9 offset:5120
    s_waitcnt lgkmcnt(6)
    v_mfma_f32_32x32x16_bf16 v[208:223], v[168:171], v[48:51], v[208:223]
    ds_read_b64_tr_b16 v[168:169], v10 offset:4096
    ds_read_b64_tr_b16 v[170:171], v10 offset:5120
    s_waitcnt lgkmcnt(6)
    v_mfma_f32_32x32x16_bf16 v[224:239], v[172:175], v[48:51], v[224:239]
    ds_read_b64_tr_b16 v[172:173], v11 offset:4096
    ds_read_b64_tr_b16 v[174:175], v11 offset:5120
    s_waitcnt vmcnt(11)
    s_waitcnt lgkmcnt(6)
    v_mfma_f32_32x32x16_bf16 v[176:191], v[160:163], v[52:55], v[176:191]
    ds_read_b64_tr_b16 v[160:161], v8 offset:8192
    ds_read_b64_tr_b16 v[162:163], v8 offset:9216
    buffer_load_dwordx4 v[100:103], v1, s[12:15], s34 offen offset:1024 sc1
    s_waitcnt lgkmcnt(6)
    v_mfma_f32_32x32x16_bf16 v[192:207], v[164:167], v[52:55], v[192:207]
    ds_read_b64_tr_b16 v[164:165], v9 offset:8192
    ds_read_b64_tr_b16 v[166:167], v9 offset:9216
    s_waitcnt lgkmcnt(6)
    v_mfma_f32_32x32x16_bf16 v[208:223], v[168:171], v[52:55], v[208:223]
    ds_read_b64_tr_b16 v[168:169], v10 offset:8192
    ds_read_b64_tr_b16 v[170:171], v10 offset:9216
    s_waitcnt lgkmcnt(6)
    v_mfma_f32_32x32x16_bf16 v[224:239], v[172:175], v[52:55], v[224:239]
    ds_read_b64_tr_b16 v[172:173], v11 offset:8192
    ds_read_b64_tr_b16 v[174:175], v11 offset:9216
    s_waitcnt vmcnt(11)
    s_waitcnt lgkmcnt(6)
    v_mfma_f32_32x32x16_bf16 v[176:191], v[160:163], v[56:59], v[176:191]
    ds_read_b64_tr_b16 v[160:161], v8 offset:12288
    ds_read_b64_tr_b16 v[162:163], v8 offset:13312
    buffer_load_dwordx4 v[104:107], v1, s[12:15], s34 offen offset:2048 sc1
    s_waitcnt lgkmcnt(6)
    v_mfma_f32_32x32x16_bf16 v[192:207], v[164:167], v[56:59], v[192:207]
    ds_read_b64_tr_b16 v[164:165], v9 offset:12288
    ds_read_b64_tr_b16 v[166:167], v9 offset:13312
    s_waitcnt lgkmcnt(6)
    v_mfma_f32_32x32x16_bf16 v[208:223], v[168:171], v[56:59], v[208:223]
    ds_read_b64_tr_b16 v[168:169], v10 offset:12288
    ds_read_b64_tr_b16 v[170:171], v10 offset:13312
    s_waitcnt lgkmcnt(6)
    v_mfma_f32_32x32x16_bf16 v[224:239], v[172:175], v[56:59], v[224:239]
    ds_read_b64_tr_b16 v[172:173], v11 offset:12288
    ds_read_b64_tr_b16 v[174:175], v11 offset:13312
    v_add_u32 v8, 16384, v8
    v_add_u32 v9, 16384, v9
    v_add_u32 v10, 16384, v10
    v_add_u32 v11, 16384, v11
    s_waitcnt vmcnt(11)
    s_waitcnt lgkmcnt(6)
    v_mfma_f32_32x32x16_bf16 v[176:191], v[160:163], v[60:63], v[176:191]
    ds_read_b64_tr_b16 v[160:161], v8 offset:0
    ds_read_b64_tr_b16 v[162:163], v8 offset:1024
    buffer_load_dwordx4 v[108:111], v1, s[12:15], s34 offen offset:3072 sc1
    s_waitcnt lgkmcnt(6)
    v_mfma_f32_32x32x16_bf16 v[192:207], v[164:167], v[60:63], v[192:207]
    ds_read_b64_tr_b16 v[164:165], v9 offset:0
    ds_read_b64_tr_b16 v[166:167], v9 offset:1024
    s_waitcnt lgkmcnt(6)
    v_mfma_f32_32x32x16_bf16 v[208:223], v[168:171], v[60:63], v[208:223]
    ds_read_b64_tr_b16 v[168:169], v10 offset:0
    ds_read_b64_tr_b16 v[170:171], v10 offset:1024
    s_waitcnt lgkmcnt(6)
    v_mfma_f32_32x32x16_bf16 v[224:239], v[172:175], v[60:63], v[224:239]
    ds_read_b64_tr_b16 v[172:173], v11 offset:0
    ds_read_b64_tr_b16 v[174:175], v11 offset:1024
    s_waitcnt vmcnt(11)
    s_waitcnt lgkmcnt(6)
    v_mfma_f32_32x32x16_bf16 v[176:191], v[160:163], v[64:67], v[176:191]
    ds_read_b64_tr_b16 v[160:161], v8 offset:4096
    ds_read_b64_tr_b16 v[162:163], v8 offset:5120
    s_add_u32 s34, s34, 4096
    buffer_load_dwordx4 v[112:115], v1, s[12:15], s34 offen offset:0 sc1
    s_waitcnt lgkmcnt(6)
    v_mfma_f32_32x32x16_bf16 v[192:207], v[164:167], v[64:67], v[192:207]
    ds_read_b64_tr_b16 v[164:165], v9 offset:4096
    ds_read_b64_tr_b16 v[166:167], v9 offset:5120
    s_waitcnt lgkmcnt(6)
    v_mfma_f32_32x32x16_bf16 v[208:223], v[168:171], v[64:67], v[208:223]
    ds_read_b64_tr_b16 v[168:169], v10 offset:4096
    ds_read_b64_tr_b16 v[170:171], v10 offset:5120
    s_waitcnt lgkmcnt(6)
    v_mfma_f32_32x32x16_bf16 v[224:239], v[172:175], v[64:67], v[224:239]
    ds_read_b64_tr_b16 v[172:173], v11 offset:4096
    ds_read_b64_tr_b16 v[174:175], v11 offset:5120
    s_waitcnt vmcnt(11)
    s_waitcnt lgkmcnt(6)
    v_mfma_f32_32x32x16_bf16 v[176:191], v[160:163], v[68:71], v[176:191]
    ds_read_b64_tr_b16 v[160:161], v8 offset:8192
    ds_read_b64_tr_b16 v[162:163], v8 offset:9216
    buffer_load_dwordx4 v[116:119], v1, s[12:15], s34 offen offset:1024 sc1
    s_waitcnt lgkmcnt(6)
    v_mfma_f32_32x32x16_bf16 v[192:207], v[164:167], v[68:71], v[192:207]
    ds_read_b64_tr_b16 v[164:165], v9 offset:8192
    ds_read_b64_tr_b16 v[166:167], v9 offset:9216
    s_waitcnt lgkmcnt(6)
    v_mfma_f32_32x32x16_bf16 v[208:223], v[168:171], v[68:71], v[208:223]
    ds_read_b64_tr_b16 v[168:169], v10 offset:8192
    ds_read_b64_tr_b16 v[170:171], v10 offset:9216
    s_waitcnt lgkmcnt(6)
    v_mfma_f32_32x32x16_bf16 v[224:239], v[172:175], v[68:71], v[224:239]
    ds_read_b64_tr_b16 v[172:173], v11 offset:8192
    ds_read_b64_tr_b16 v[174:175], v11 offset:9216
    s_waitcnt vmcnt(11)
    s_waitcnt lgkmcnt(6)
    v_mfma_f32_32x32x16_bf16 v[176:191], v[160:163], v[72:75], v[176:191]
    ds_read_b64_tr_b16 v[160:161], v8 offset:12288
    ds_read_b64_tr_b16 v[162:163], v8 offset:13312
    buffer_load_dwordx4 v[120:123], v1, s[12:15], s34 offen offset:2048 sc1
    s_waitcnt lgkmcnt(6)
    v_mfma_f32_32x32x16_bf16 v[192:207], v[164:167], v[72:75], v[192:207]
    ds_read_b64_tr_b16 v[164:165], v9 offset:12288
    ds_read_b64_tr_b16 v[166:167], v9 offset:13312
    s_waitcnt lgkmcnt(6)
    v_mfma_f32_32x32x16_bf16 v[208:223], v[168:171], v[72:75], v[208:223]
    ds_read_b64_tr_b16 v[168:169], v10 offset:12288
    ds_read_b64_tr_b16 v[170:171], v10 offset:13312
    s_waitcnt lgkmcnt(6)
    v_mfma_f32_32x32x16_bf16 v[224:239], v[172:175], v[72:75], v[224:239]
    ds_read_b64_tr_b16 v[172:173], v11 offset:12288
    ds_read_b64_tr_b16 v[174:175], v11 offset:13312
    v_add_u32 v8, 16384, v8
    v_add_u32 v9, 16384, v9
    v_add_u32 v10, 16384, v10
    v_add_u32 v11, 16384, v11
    s_waitcnt vmcnt(11)
    s_waitcnt lgkmcnt(6)
    v_mfma_f32_32x32x16_bf16 v[176:191], v[160:163], v[76:79], v[176:191]
    ds_read_b64_tr_b16 v[160:161], v8 offset:0
    ds_read_b64_tr_b16 v[162:163], v8 offset:1024
    buffer_load_dwordx4 v[124:127], v1, s[12:15], s34 offen offset:3072 sc1
    s_waitcnt lgkmcnt(6)
    v_mfma_f32_32x32x16_bf16 v[192:207], v[164:167], v[76:79], v[192:207]
    ds_read_b64_tr_b16 v[164:165], v9 offset:0
    ds_read_b64_tr_b16 v[166:167], v9 offset:1024
    s_waitcnt lgkmcnt(6)
    v_mfma_f32_32x32x16_bf16 v[208:223], v[168:171], v[76:79], v[208:223]
    ds_read_b64_tr_b16 v[168:169], v10 offset:0
    ds_read_b64_tr_b16 v[170:171], v10 offset:1024
    s_waitcnt lgkmcnt(6)
    v_mfma_f32_32x32x16_bf16 v[224:239], v[172:175], v[76:79], v[224:239]
    ds_read_b64_tr_b16 v[172:173], v11 offset:0
    ds_read_b64_tr_b16 v[174:175], v11 offset:1024
    s_waitcnt vmcnt(11)
    s_waitcnt lgkmcnt(6)
    v_mfma_f32_32x32x16_bf16 v[176:191], v[160:163], v[80:83], v[176:191]
    ds_read_b64_tr_b16 v[160:161], v8 offset:4096
    ds_read_b64_tr_b16 v[162:163], v8 offset:5120
    s_add_u32 s34, s34, 4096
    buffer_load_dwordx4 v[128:131], v1, s[12:15], s34 offen offset:0 sc1
    s_waitcnt lgkmcnt(6)
    v_mfma_f32_32x32x16_bf16 v[192:207], v[164:167], v[80:83], v[192:207]
    ds_read_b64_tr_b16 v[164:165], v9 offset:4096
    ds_read_b64_tr_b16 v[166:167], v9 offset:5120
    s_waitcnt lgkmcnt(6)
    v_mfma_f32_32x32x16_bf16 v[208:223], v[168:171], v[80:83], v[208:223]
    ds_read_b64_tr_b16 v[168:169], v10 offset:4096
    ds_read_b64_tr_b16 v[170:171], v10 offset:5120
    s_waitcnt lgkmcnt(6)
    v_mfma_f32_32x32x16_bf16 v[224:239], v[172:175], v[80:83], v[224:239]
    ds_read_b64_tr_b16 v[172:173], v11 offset:4096
    ds_read_b64_tr_b16 v[174:175], v11 offset:5120
    s_waitcnt vmcnt(11)
    s_waitcnt lgkmcnt(6)
    v_mfma_f32_32x32x16_bf16 v[176:191], v[160:163], v[84:87], v[176:191]
    ds_read_b64_tr_b16 v[160:161], v8 offset:8192
    ds_read_b64_tr_b16 v[162:163], v8 offset:9216
    buffer_load_dwordx4 v[132:135], v1, s[12:15], s34 offen offset:1024 sc1
    s_waitcnt lgkmcnt(6)
    v_mfma_f32_32x32x16_bf16 v[192:207], v[164:167], v[84:87], v[192:207]
    ds_read_b64_tr_b16 v[164:165], v9 offset:8192
    ds_read_b64_tr_b16 v[166:167], v9 offset:9216
    s_waitcnt lgkmcnt(6)
    v_mfma_f32_32x32x16_bf16 v[208:223], v[168:171], v[84:87], v[208:223]
    ds_read_b64_tr_b16 v[168:169], v10 offset:8192
    ds_read_b64_tr_b16 v[170:171], v10 offset:9216
    s_waitcnt lgkmcnt(6)
    v_mfma_f32_32x32x16_bf16 v[224:239], v[172:175], v[84:87], v[224:239]
    ds_read_b64_tr_b16 v[172:173], v11 offset:8192
    ds_read_b64_tr_b16 v[174:175], v11 offset:9216
    s_waitcnt vmcnt(11)
    s_waitcnt lgkmcnt(6)
    v_mfma_f32_32x32x16_bf16 v[176:191], v[160:163], v[88:91], v[176:191]
    ds_read_b64_tr_b16 v[160:161], v8 offset:12288
    ds_read_b64_tr_b16 v[162:163], v8 offset:13312
    buffer_load_dwordx4 v[136:139], v1, s[12:15], s34 offen offset:2048 sc1
    s_waitcnt lgkmcnt(6)
    v_mfma_f32_32x32x16_bf16 v[192:207], v[164:167], v[88:91], v[192:207]
    ds_read_b64_tr_b16 v[164:165], v9 offset:12288
    ds_read_b64_tr_b16 v[166:167], v9 offset:13312
    s_waitcnt lgkmcnt(6)
    v_mfma_f32_32x32x16_bf16 v[208:223], v[168:171], v[88:91], v[208:223]
    ds_read_b64_tr_b16 v[168:169], v10 offset:12288
    ds_read_b64_tr_b16 v[170:171], v10 offset:13312
    s_waitcnt lgkmcnt(6)
    v_mfma_f32_32x32x16_bf16 v[224:239], v[172:175], v[88:91], v[224:239]
    ds_read_b64_tr_b16 v[172:173], v11 offset:12288
    ds_read_b64_tr_b16 v[174:175], v11 offset:13312
    v_add_u32 v8, 16384, v8
    v_add_u32 v9, 16384, v9
    v_add_u32 v10, 16384, v10
    v_add_u32 v11, 16384, v11
    s_waitcnt vmcnt(11)
    s_waitcnt lgkmcnt(6)
    v_mfma_f32_32x32x16_bf16 v[176:191], v[160:163], v[92:95], v[176:191]
    ds_read_b64_tr_b16 v[160:161], v8 offset:0
    ds_read_b64_tr_b16 v[162:163], v8 offset:1024
    buffer_load_dwordx4 v[140:143], v1, s[12:15], s34 offen offset:3072 sc1
    s_waitcnt lgkmcnt(6)
    v_mfma_f32_32x32x16_bf16 v[192:207], v[164:167], v[92:95], v[192:207]
    ds_read_b64_tr_b16 v[164:165], v9 offset:0
    ds_read_b64_tr_b16 v[166:167], v9 offset:1024
    s_waitcnt lgkmcnt(6)
    v_mfma_f32_32x32x16_bf16 v[208:223], v[168:171], v[92:95], v[208:223]
    ds_read_b64_tr_b16 v[168:169], v10 offset:0
    ds_read_b64_tr_b16 v[170:171], v10 offset:1024
    s_waitcnt lgkmcnt(6)
    v_mfma_f32_32x32x16_bf16 v[224:239], v[172:175], v[92:95], v[224:239]
    ds_read_b64_tr_b16 v[172:173], v11 offset:0
    ds_read_b64_tr_b16 v[174:175], v11 offset:1024
    s_waitcnt vmcnt(11)
    s_waitcnt lgkmcnt(6)
    v_mfma_f32_32x32x16_bf16 v[176:191], v[160:163], v[96:99], v[176:191]
    ds_read_b64_tr_b16 v[160:161], v8 offset:4096
    ds_read_b64_tr_b16 v[162:163], v8 offset:5120
    s_add_u32 s34, s34, 4096
    buffer_load_dwordx4 v[144:147], v1, s[12:15], s34 offen offset:0 sc1
    s_waitcnt lgkmcnt(6)
    v_mfma_f32_32x32x16_bf16 v[192:207], v[164:167], v[96:99], v[192:207]
    ds_read_b64_tr_b16 v[164:165], v9 offset:4096
    ds_read_b64_tr_b16 v[166:167], v9 offset:5120
    s_waitcnt lgkmcnt(6)
    v_mfma_f32_32x32x16_bf16 v[208:223], v[168:171], v[96:99], v[208:223]
    ds_read_b64_tr_b16 v[168:169], v10 offset:4096
    ds_read_b64_tr_b16 v[170:171], v10 offset:5120
    s_waitcnt lgkmcnt(6)
    v_mfma_f32_32x32x16_bf16 v[224:239], v[172:175], v[96:99], v[224:239]
    ds_read_b64_tr_b16 v[172:173], v11 offset:4096
    ds_read_b64_tr_b16 v[174:175], v11 offset:5120
    s_waitcnt vmcnt(11)
    s_waitcnt lgkmcnt(6)
    v_mfma_f32_32x32x16_bf16 v[176:191], v[160:163], v[100:103], v[176:191]
    ds_read_b64_tr_b16 v[160:161], v8 offset:8192
    ds_read_b64_tr_b16 v[162:163], v8 offset:9216
    buffer_load_dwordx4 v[148:151], v1, s[12:15], s34 offen offset:1024 sc1
    s_waitcnt lgkmcnt(6)
    v_mfma_f32_32x32x16_bf16 v[192:207], v[164:167], v[100:103], v[192:207]
    ds_read_b64_tr_b16 v[164:165], v9 offset:8192
    ds_read_b64_tr_b16 v[166:167], v9 offset:9216
    s_waitcnt lgkmcnt(6)
    v_mfma_f32_32x32x16_bf16 v[208:223], v[168:171], v[100:103], v[208:223]
    ds_read_b64_tr_b16 v[168:169], v10 offset:8192
    ds_read_b64_tr_b16 v[170:171], v10 offset:9216
    s_waitcnt lgkmcnt(6)
    v_mfma_f32_32x32x16_bf16 v[224:239], v[172:175], v[100:103], v[224:239]
    ds_read_b64_tr_b16 v[172:173], v11 offset:8192
    ds_read_b64_tr_b16 v[174:175], v11 offset:9216
    s_waitcnt vmcnt(11)
    s_waitcnt lgkmcnt(6)
    v_mfma_f32_32x32x16_bf16 v[176:191], v[160:163], v[104:107], v[176:191]
    ds_read_b64_tr_b16 v[160:161], v8 offset:12288
    ds_read_b64_tr_b16 v[162:163], v8 offset:13312
    buffer_load_dwordx4 v[152:155], v1, s[12:15], s34 offen offset:2048 sc1
    s_waitcnt lgkmcnt(6)
    v_mfma_f32_32x32x16_bf16 v[192:207], v[164:167], v[104:107], v[192:207]
    ds_read_b64_tr_b16 v[164:165], v9 offset:12288
    ds_read_b64_tr_b16 v[166:167], v9 offset:13312
    s_waitcnt lgkmcnt(6)
    v_mfma_f32_32x32x16_bf16 v[208:223], v[168:171], v[104:107], v[208:223]
    ds_read_b64_tr_b16 v[168:169], v10 offset:12288
    ds_read_b64_tr_b16 v[170:171], v10 offset:13312
    s_waitcnt lgkmcnt(6)
    v_mfma_f32_32x32x16_bf16 v[224:239], v[172:175], v[104:107], v[224:239]
    ds_read_b64_tr_b16 v[172:173], v11 offset:12288
    ds_read_b64_tr_b16 v[174:175], v11 offset:13312
    s_barrier
    v_add_u32 v8, 16384, v8
    v_add_u32 v9, 16384, v9
    v_add_u32 v10, 16384, v10
    v_add_u32 v11, 16384, v11
    s_waitcnt vmcnt(11)
    s_waitcnt lgkmcnt(6)
    v_mfma_f32_32x32x16_bf16 v[176:191], v[160:163], v[108:111], v[176:191]
    ds_read_b64_tr_b16 v[160:161], v8 offset:0
    ds_read_b64_tr_b16 v[162:163], v8 offset:1024
    buffer_load_dwordx4 v[156:159], v1, s[12:15], s34 offen offset:3072 sc1
    s_waitcnt lgkmcnt(6)
    v_mfma_f32_32x32x16_bf16 v[192:207], v[164:167], v[108:111], v[192:207]
    ds_read_b64_tr_b16 v[164:165], v9 offset:0
    ds_read_b64_tr_b16 v[166:167], v9 offset:1024
    s_waitcnt lgkmcnt(6)
    v_mfma_f32_32x32x16_bf16 v[208:223], v[168:171], v[108:111], v[208:223]
    ds_read_b64_tr_b16 v[168:169], v10 offset:0
    ds_read_b64_tr_b16 v[170:171], v10 offset:1024
    s_waitcnt lgkmcnt(6)
    v_mfma_f32_32x32x16_bf16 v[224:239], v[172:175], v[108:111], v[224:239]
    ds_read_b64_tr_b16 v[172:173], v11 offset:0
    ds_read_b64_tr_b16 v[174:175], v11 offset:1024
    s_waitcnt vmcnt(11)
    s_waitcnt lgkmcnt(6)
    v_mfma_f32_32x32x16_bf16 v[176:191], v[160:163], v[112:115], v[176:191]
    ds_read_b64_tr_b16 v[160:161], v8 offset:4096
    ds_read_b64_tr_b16 v[162:163], v8 offset:5120
    s_waitcnt lgkmcnt(6)
    v_mfma_f32_32x32x16_bf16 v[192:207], v[164:167], v[112:115], v[192:207]
    ds_read_b64_tr_b16 v[164:165], v9 offset:4096
    ds_read_b64_tr_b16 v[166:167], v9 offset:5120
    s_waitcnt lgkmcnt(6)
    v_mfma_f32_32x32x16_bf16 v[208:223], v[168:171], v[112:115], v[208:223]
    ds_read_b64_tr_b16 v[168:169], v10 offset:4096
    ds_read_b64_tr_b16 v[170:171], v10 offset:5120
    s_waitcnt lgkmcnt(6)
    v_mfma_f32_32x32x16_bf16 v[224:239], v[172:175], v[112:115], v[224:239]
    ds_read_b64_tr_b16 v[172:173], v11 offset:4096
    ds_read_b64_tr_b16 v[174:175], v11 offset:5120
    s_waitcnt vmcnt(10)
    s_waitcnt lgkmcnt(6)
    v_mfma_f32_32x32x16_bf16 v[176:191], v[160:163], v[116:119], v[176:191]
    ds_read_b64_tr_b16 v[160:161], v8 offset:8192
    ds_read_b64_tr_b16 v[162:163], v8 offset:9216
    s_waitcnt lgkmcnt(6)
    v_mfma_f32_32x32x16_bf16 v[192:207], v[164:167], v[116:119], v[192:207]
    ds_read_b64_tr_b16 v[164:165], v9 offset:8192
    ds_read_b64_tr_b16 v[166:167], v9 offset:9216
    s_waitcnt lgkmcnt(6)
    v_mfma_f32_32x32x16_bf16 v[208:223], v[168:171], v[116:119], v[208:223]
    ds_read_b64_tr_b16 v[168:169], v10 offset:8192
    ds_read_b64_tr_b16 v[170:171], v10 offset:9216
    s_waitcnt lgkmcnt(6)
    v_mfma_f32_32x32x16_bf16 v[224:239], v[172:175], v[116:119], v[224:239]
    ds_read_b64_tr_b16 v[172:173], v11 offset:8192
    ds_read_b64_tr_b16 v[174:175], v11 offset:9216
    s_waitcnt vmcnt(9)
    s_waitcnt lgkmcnt(6)
    v_mfma_f32_32x32x16_bf16 v[176:191], v[160:163], v[120:123], v[176:191]
    ds_read_b64_tr_b16 v[160:161], v8 offset:12288
    ds_read_b64_tr_b16 v[162:163], v8 offset:13312
    s_waitcnt lgkmcnt(6)
    v_mfma_f32_32x32x16_bf16 v[192:207], v[164:167], v[120:123], v[192:207]
    ds_read_b64_tr_b16 v[164:165], v9 offset:12288
    ds_read_b64_tr_b16 v[166:167], v9 offset:13312
    s_waitcnt lgkmcnt(6)
    v_mfma_f32_32x32x16_bf16 v[208:223], v[168:171], v[120:123], v[208:223]
    ds_read_b64_tr_b16 v[168:169], v10 offset:12288
    ds_read_b64_tr_b16 v[170:171], v10 offset:13312
    s_waitcnt lgkmcnt(6)
    v_mfma_f32_32x32x16_bf16 v[224:239], v[172:175], v[120:123], v[224:239]
    ds_read_b64_tr_b16 v[172:173], v11 offset:12288
    ds_read_b64_tr_b16 v[174:175], v11 offset:13312
    v_add_u32 v8, 16384, v8
    v_add_u32 v9, 16384, v9
    v_add_u32 v10, 16384, v10
    v_add_u32 v11, 16384, v11
    s_waitcnt vmcnt(8)
    s_waitcnt lgkmcnt(6)
    v_mfma_f32_32x32x16_bf16 v[176:191], v[160:163], v[124:127], v[176:191]
    ds_read_b64_tr_b16 v[160:161], v8 offset:0
    ds_read_b64_tr_b16 v[162:163], v8 offset:1024
    s_waitcnt lgkmcnt(6)
    v_mfma_f32_32x32x16_bf16 v[192:207], v[164:167], v[124:127], v[192:207]
    ds_read_b64_tr_b16 v[164:165], v9 offset:0
    ds_read_b64_tr_b16 v[166:167], v9 offset:1024
    s_waitcnt lgkmcnt(6)
    v_mfma_f32_32x32x16_bf16 v[208:223], v[168:171], v[124:127], v[208:223]
    ds_read_b64_tr_b16 v[168:169], v10 offset:0
    ds_read_b64_tr_b16 v[170:171], v10 offset:1024
    s_waitcnt lgkmcnt(6)
    v_mfma_f32_32x32x16_bf16 v[224:239], v[172:175], v[124:127], v[224:239]
    ds_read_b64_tr_b16 v[172:173], v11 offset:0
    ds_read_b64_tr_b16 v[174:175], v11 offset:1024
    s_waitcnt vmcnt(7)
    s_waitcnt lgkmcnt(6)
    v_mfma_f32_32x32x16_bf16 v[176:191], v[160:163], v[128:131], v[176:191]
    ds_read_b64_tr_b16 v[160:161], v8 offset:4096
    ds_read_b64_tr_b16 v[162:163], v8 offset:5120
    s_waitcnt lgkmcnt(6)
    v_mfma_f32_32x32x16_bf16 v[192:207], v[164:167], v[128:131], v[192:207]
    ds_read_b64_tr_b16 v[164:165], v9 offset:4096
    ds_read_b64_tr_b16 v[166:167], v9 offset:5120
    s_waitcnt lgkmcnt(6)
    v_mfma_f32_32x32x16_bf16 v[208:223], v[168:171], v[128:131], v[208:223]
    ds_read_b64_tr_b16 v[168:169], v10 offset:4096
    ds_read_b64_tr_b16 v[170:171], v10 offset:5120
    s_waitcnt lgkmcnt(6)
    v_mfma_f32_32x32x16_bf16 v[224:239], v[172:175], v[128:131], v[224:239]
    ds_read_b64_tr_b16 v[172:173], v11 offset:4096
    ds_read_b64_tr_b16 v[174:175], v11 offset:5120
    s_waitcnt vmcnt(6)
    s_waitcnt lgkmcnt(6)
    v_mfma_f32_32x32x16_bf16 v[176:191], v[160:163], v[132:135], v[176:191]
    ds_read_b64_tr_b16 v[160:161], v8 offset:8192
    ds_read_b64_tr_b16 v[162:163], v8 offset:9216
    s_waitcnt lgkmcnt(6)
    v_mfma_f32_32x32x16_bf16 v[192:207], v[164:167], v[132:135], v[192:207]
    ds_read_b64_tr_b16 v[164:165], v9 offset:8192
    ds_read_b64_tr_b16 v[166:167], v9 offset:9216
    s_waitcnt lgkmcnt(6)
    v_mfma_f32_32x32x16_bf16 v[208:223], v[168:171], v[132:135], v[208:223]
    ds_read_b64_tr_b16 v[168:169], v10 offset:8192
    ds_read_b64_tr_b16 v[170:171], v10 offset:9216
    s_waitcnt lgkmcnt(6)
    v_mfma_f32_32x32x16_bf16 v[224:239], v[172:175], v[132:135], v[224:239]
    ds_read_b64_tr_b16 v[172:173], v11 offset:8192
    ds_read_b64_tr_b16 v[174:175], v11 offset:9216
    s_waitcnt vmcnt(5)
    s_waitcnt lgkmcnt(6)
    v_mfma_f32_32x32x16_bf16 v[176:191], v[160:163], v[136:139], v[176:191]
    ds_read_b64_tr_b16 v[160:161], v8 offset:12288
    ds_read_b64_tr_b16 v[162:163], v8 offset:13312
    s_waitcnt lgkmcnt(6)
    v_mfma_f32_32x32x16_bf16 v[192:207], v[164:167], v[136:139], v[192:207]
    ds_read_b64_tr_b16 v[164:165], v9 offset:12288
    ds_read_b64_tr_b16 v[166:167], v9 offset:13312
    s_waitcnt lgkmcnt(6)
    v_mfma_f32_32x32x16_bf16 v[208:223], v[168:171], v[136:139], v[208:223]
    ds_read_b64_tr_b16 v[168:169], v10 offset:12288
    ds_read_b64_tr_b16 v[170:171], v10 offset:13312
    s_waitcnt lgkmcnt(6)
    v_mfma_f32_32x32x16_bf16 v[224:239], v[172:175], v[136:139], v[224:239]
    ds_read_b64_tr_b16 v[172:173], v11 offset:12288
    ds_read_b64_tr_b16 v[174:175], v11 offset:13312
    v_add_u32 v8, 16384, v8
    v_add_u32 v9, 16384, v9
    v_add_u32 v10, 16384, v10
    v_add_u32 v11, 16384, v11
    s_waitcnt vmcnt(4)
    s_waitcnt lgkmcnt(6)
    v_mfma_f32_32x32x16_bf16 v[176:191], v[160:163], v[140:143], v[176:191]
    ds_read_b64_tr_b16 v[160:161], v8 offset:0
    ds_read_b64_tr_b16 v[162:163], v8 offset:1024
    s_waitcnt lgkmcnt(6)
    v_mfma_f32_32x32x16_bf16 v[192:207], v[164:167], v[140:143], v[192:207]
    ds_read_b64_tr_b16 v[164:165], v9 offset:0
    ds_read_b64_tr_b16 v[166:167], v9 offset:1024
    s_waitcnt lgkmcnt(6)
    v_mfma_f32_32x32x16_bf16 v[208:223], v[168:171], v[140:143], v[208:223]
    ds_read_b64_tr_b16 v[168:169], v10 offset:0
    ds_read_b64_tr_b16 v[170:171], v10 offset:1024
    s_waitcnt lgkmcnt(6)
    v_mfma_f32_32x32x16_bf16 v[224:239], v[172:175], v[140:143], v[224:239]
    ds_read_b64_tr_b16 v[172:173], v11 offset:0
    ds_read_b64_tr_b16 v[174:175], v11 offset:1024
    s_waitcnt vmcnt(3)
    s_waitcnt lgkmcnt(6)
    v_mfma_f32_32x32x16_bf16 v[176:191], v[160:163], v[144:147], v[176:191]
    ds_read_b64_tr_b16 v[160:161], v8 offset:4096
    ds_read_b64_tr_b16 v[162:163], v8 offset:5120
    s_waitcnt lgkmcnt(6)
    v_mfma_f32_32x32x16_bf16 v[192:207], v[164:167], v[144:147], v[192:207]
    ds_read_b64_tr_b16 v[164:165], v9 offset:4096
    ds_read_b64_tr_b16 v[166:167], v9 offset:5120
    s_waitcnt lgkmcnt(6)
    v_mfma_f32_32x32x16_bf16 v[208:223], v[168:171], v[144:147], v[208:223]
    ds_read_b64_tr_b16 v[168:169], v10 offset:4096
    ds_read_b64_tr_b16 v[170:171], v10 offset:5120
    s_waitcnt lgkmcnt(6)
    v_mfma_f32_32x32x16_bf16 v[224:239], v[172:175], v[144:147], v[224:239]
    ds_read_b64_tr_b16 v[172:173], v11 offset:4096
    ds_read_b64_tr_b16 v[174:175], v11 offset:5120
    s_waitcnt vmcnt(2)
    s_waitcnt lgkmcnt(6)
    v_mfma_f32_32x32x16_bf16 v[176:191], v[160:163], v[148:151], v[176:191]
    ds_read_b64_tr_b16 v[160:161], v8 offset:8192
    ds_read_b64_tr_b16 v[162:163], v8 offset:9216
    s_waitcnt lgkmcnt(6)
    v_mfma_f32_32x32x16_bf16 v[192:207], v[164:167], v[148:151], v[192:207]
    ds_read_b64_tr_b16 v[164:165], v9 offset:8192
    ds_read_b64_tr_b16 v[166:167], v9 offset:9216
    s_waitcnt lgkmcnt(6)
    v_mfma_f32_32x32x16_bf16 v[208:223], v[168:171], v[148:151], v[208:223]
    ds_read_b64_tr_b16 v[168:169], v10 offset:8192
    ds_read_b64_tr_b16 v[170:171], v10 offset:9216
    s_waitcnt lgkmcnt(6)
    v_mfma_f32_32x32x16_bf16 v[224:239], v[172:175], v[148:151], v[224:239]
    ds_read_b64_tr_b16 v[172:173], v11 offset:8192
    ds_read_b64_tr_b16 v[174:175], v11 offset:9216
    s_waitcnt vmcnt(1)
    s_waitcnt lgkmcnt(6)
    v_mfma_f32_32x32x16_bf16 v[176:191], v[160:163], v[152:155], v[176:191]
    ds_read_b64_tr_b16 v[160:161], v8 offset:12288
    ds_read_b64_tr_b16 v[162:163], v8 offset:13312
    s_waitcnt lgkmcnt(6)
    v_mfma_f32_32x32x16_bf16 v[192:207], v[164:167], v[152:155], v[192:207]
    ds_read_b64_tr_b16 v[164:165], v9 offset:12288
    ds_read_b64_tr_b16 v[166:167], v9 offset:13312
    s_waitcnt lgkmcnt(6)
    v_mfma_f32_32x32x16_bf16 v[208:223], v[168:171], v[152:155], v[208:223]
    ds_read_b64_tr_b16 v[168:169], v10 offset:12288
    ds_read_b64_tr_b16 v[170:171], v10 offset:13312
    s_waitcnt lgkmcnt(6)
    v_mfma_f32_32x32x16_bf16 v[224:239], v[172:175], v[152:155], v[224:239]
    ds_read_b64_tr_b16 v[172:173], v11 offset:12288
    ds_read_b64_tr_b16 v[174:175], v11 offset:13312
    s_waitcnt vmcnt(0)
    s_waitcnt lgkmcnt(6)
    v_mfma_f32_32x32x16_bf16 v[176:191], v[160:163], v[156:159], v[176:191]
    ds_read_b64_tr_b16 v[160:161], v8 offset:0
    ds_read_b64_tr_b16 v[162:163], v8 offset:1024
    s_waitcnt lgkmcnt(6)
    v_mfma_f32_32x32x16_bf16 v[192:207], v[164:167], v[156:159], v[192:207]
    ds_read_b64_tr_b16 v[164:165], v9 offset:0
    ds_read_b64_tr_b16 v[166:167], v9 offset:1024
    s_waitcnt lgkmcnt(6)
    v_mfma_f32_32x32x16_bf16 v[208:223], v[168:171], v[156:159], v[208:223]
    ds_read_b64_tr_b16 v[168:169], v10 offset:0
    ds_read_b64_tr_b16 v[170:171], v10 offset:1024
    s_waitcnt lgkmcnt(6)
    v_mfma_f32_32x32x16_bf16 v[224:239], v[172:175], v[156:159], v[224:239]
    ds_read_b64_tr_b16 v[172:173], v11 offset:0
    ds_read_b64_tr_b16 v[174:175], v11 offset:1024
    s_waitcnt lgkmcnt(0)
    ds_read_b64 v[32:33], v14 offset:0
    ds_read_b64 v[34:35], v14 offset:1024
    ds_read_b64 v[36:37], v14 offset:2048
    ds_read_b64 v[38:39], v14 offset:3072
    ds_read_b64 v[40:41], v14 offset:4096
    ds_read_b64 v[42:43], v14 offset:5120
    ds_read_b64 v[44:45], v14 offset:6144
    ds_read_b64 v[46:47], v14 offset:7168
    ds_read_b128 v[128:131], v16 offset:0
    ds_read_b128 v[132:135], v16 offset:32
    ds_read_b128 v[136:139], v16 offset:64
    ds_read_b128 v[140:143], v16 offset:96
    s_waitcnt lgkmcnt(4)
    ds_read_b128 v[144:147], v16 offset:128
    ds_read_b128 v[148:151], v16 offset:160
    ds_read_b128 v[152:155], v16 offset:192
    ds_read_b128 v[156:159], v16 offset:224
    ds_read_b128 v[64:67], v15 offset:0
    ds_read_b128 v[68:71], v15 offset:16
    ds_read_b128 v[72:75], v15 offset:64
    ds_read_b128 v[76:79], v15 offset:80
    v_pk_add_f32 v[32:33], v[32:33], v[34:35]
    v_pk_add_f32 v[32:33], v[32:33], v[36:37]
    v_pk_add_f32 v[32:33], v[32:33], v[38:39]
    v_pk_add_f32 v[32:33], v[32:33], v[40:41]
    v_pk_add_f32 v[32:33], v[32:33], v[42:43]
    v_pk_add_f32 v[32:33], v[32:33], v[44:45]
    v_pk_add_f32 v[32:33], v[32:33], v[46:47]
    v_mov_b32 v34, v32
    v_mov_b32 v35, v33
    s_nop 1
    v_permlane32_swap_b32 v32, v34
    v_permlane32_swap_b32 v33, v35
    s_nop 1
    v_add_f32 v32, v32, v34
    v_add_f32 v33, v33, v35
    v_mul_f32 v32, 0x3b000000, v32
    v_mul_f32 v33, 0x3b000000, v33
    v_fma_f32 v33, -v32, v32, v33
    v_max_f32 v33, 0, v33
    v_add_f32 v33, 0x3727c5ac, v33
    v_rsq_f32 v24, v33
    s_waitcnt lgkmcnt(4)
    ds_read_b128 v[80:83], v15 offset:128
    ds_read_b128 v[84:87], v15 offset:144
    ds_read_b128 v[88:91], v15 offset:192
    ds_read_b128 v[92:95], v15 offset:208
    ds_read_b128 v[96:99], v15 offset:256
    ds_read_b128 v[100:103], v15 offset:272
    ds_read_b128 v[104:107], v15 offset:320
    ds_read_b128 v[108:111], v15 offset:336
    v_mul_f32 v25, v32, v24
    v_sub_f32 v25, 0, v25
    v_mov_b32 v12, 0xc0135761
    v_mov_b32 v13, 0xbdd2d3e8
    s_mul_i32 s35, s33, 112
    s_lshl_b32 s9, s31, 3
    s_add_u32 s35, s35, s9
    s_lshl_b32 s35, s35, 10
    s_add_u32 s35, s35, 0xa00000
    s_waitcnt lgkmcnt(8)
    v_lshlrev_b32 v48, 16, v128
    v_and_b32 v49, v17, v128
    v_lshlrev_b32 v50, 16, v129
    v_and_b32 v51, v17, v129
    v_lshlrev_b32 v52, 16, v130
    v_and_b32 v53, v17, v130
    v_lshlrev_b32 v54, 16, v131
    v_and_b32 v55, v17, v131
    v_lshlrev_b32 v56, 16, v132
    v_and_b32 v57, v17, v132
    v_lshlrev_b32 v58, 16, v133
    v_and_b32 v59, v17, v133
    v_lshlrev_b32 v60, 16, v134
    v_and_b32 v61, v17, v134
    v_lshlrev_b32 v62, 16, v135
    v_and_b32 v63, v17, v135
    v_pk_fma_f32 v[32:33], v[64:65], v[24:25], v[48:49] op_sel:[0,1,0] op_sel_hi:[1,1,1]
    v_pk_fma_f32 v[34:35], v[66:67], v[24:25], v[50:51] op_sel:[0,1,0] op_sel_hi:[1,1,1]
    v_pk_fma_f32 v[36:37], v[68:69], v[24:25], v[52:53] op_sel:[0,1,0] op_sel_hi:[1,1,1]
    v_pk_fma_f32 v[38:39], v[70:71], v[24:25], v[54:55] op_sel:[0,1,0] op_sel_hi:[1,1,1]
    v_pk_fma_f32 v[40:41], v[72:73], v[24:25], v[56:57] op_sel:[0,1,0] op_sel_hi:[1,1,1]
    v_pk_fma_f32 v[42:43], v[74:75], v[24:25], v[58:59] op_sel:[0,1,0] op_sel_hi:[1,1,1]
    v_pk_fma_f32 v[44:45], v[76:77], v[24:25], v[60:61] op_sel:[0,1,0] op_sel_hi:[1,1,1]
    v_pk_fma_f32 v[46:47], v[78:79], v[24:25], v[62:63] op_sel:[0,1,0] op_sel_hi:[1,1,1]
    v_pk_fma_f32 v[176:177], v[176:177], v[24:25], v[32:33] op_sel_hi:[1,0,1]
    v_pk_fma_f32 v[178:179], v[178:179], v[24:25], v[34:35] op_sel_hi:[1,0,1]
    v_pk_fma_f32 v[180:181], v[180:181], v[24:25], v[36:37] op_sel_hi:[1,0,1]
    v_pk_fma_f32 v[182:183], v[182:183], v[24:25], v[38:39] op_sel_hi:[1,0,1]
    v_pk_fma_f32 v[184:185], v[184:185], v[24:25], v[40:41] op_sel_hi:[1,0,1]
    v_pk_fma_f32 v[186:187], v[186:187], v[24:25], v[42:43] op_sel_hi:[1,0,1]
    v_pk_fma_f32 v[188:189], v[188:189], v[24:25], v[44:45] op_sel_hi:[1,0,1]
    v_pk_fma_f32 v[190:191], v[190:191], v[24:25], v[46:47] op_sel_hi:[1,0,1]
    v_pk_mul_f32 v[32:33], v[176:177], v[176:177]
    v_pk_mul_f32 v[34:35], v[178:179], v[178:179]
    v_pk_mul_f32 v[36:37], v[180:181], v[180:181]
    v_pk_mul_f32 v[38:39], v[182:183], v[182:183]
    v_pk_mul_f32 v[40:41], v[184:185], v[184:185]
    v_pk_mul_f32 v[42:43], v[186:187], v[186:187]
    v_pk_mul_f32 v[44:45], v[188:189], v[188:189]
    v_pk_mul_f32 v[46:47], v[190:191], v[190:191]
    v_pk_fma_f32 v[32:33], v[32:33], v[12:13], v[12:13] op_sel:[0,1,0] op_sel_hi:[1,1,0]
    v_pk_fma_f32 v[34:35], v[34:35], v[12:13], v[12:13] op_sel:[0,1,0] op_sel_hi:[1,1,0]
    v_pk_fma_f32 v[36:37], v[36:37], v[12:13], v[12:13] op_sel:[0,1,0] op_sel_hi:[1,1,0]
    v_pk_fma_f32 v[38:39], v[38:39], v[12:13], v[12:13] op_sel:[0,1,0] op_sel_hi:[1,1,0]
    v_pk_fma_f32 v[40:41], v[40:41], v[12:13], v[12:13] op_sel:[0,1,0] op_sel_hi:[1,1,0]
    v_pk_fma_f32 v[42:43], v[42:43], v[12:13], v[12:13] op_sel:[0,1,0] op_sel_hi:[1,1,0]
    v_pk_fma_f32 v[44:45], v[44:45], v[12:13], v[12:13] op_sel:[0,1,0] op_sel_hi:[1,1,0]
    v_pk_fma_f32 v[46:47], v[46:47], v[12:13], v[12:13] op_sel:[0,1,0] op_sel_hi:[1,1,0]
    v_pk_mul_f32 v[32:33], v[32:33], v[176:177]
    v_pk_mul_f32 v[34:35], v[34:35], v[178:179]
    v_pk_mul_f32 v[36:37], v[36:37], v[180:181]
    v_pk_mul_f32 v[38:39], v[38:39], v[182:183]
    v_pk_mul_f32 v[40:41], v[40:41], v[184:185]
    v_pk_mul_f32 v[42:43], v[42:43], v[186:187]
    v_pk_mul_f32 v[44:45], v[44:45], v[188:189]
    v_pk_mul_f32 v[46:47], v[46:47], v[190:191]
    v_exp_f32 v32, v32
    v_exp_f32 v33, v33
    v_exp_f32 v34, v34
    v_exp_f32 v35, v35
    v_exp_f32 v36, v36
    v_exp_f32 v37, v37
    v_exp_f32 v38, v38
    v_exp_f32 v39, v39
    v_exp_f32 v40, v40
    v_exp_f32 v41, v41
    v_exp_f32 v42, v42
    v_exp_f32 v43, v43
    v_exp_f32 v44, v44
    v_exp_f32 v45, v45
    v_exp_f32 v46, v46
    v_exp_f32 v47, v47
    v_pk_add_f32 v[32:33], v[32:33], 1.0 op_sel_hi:[1,0]
    v_pk_add_f32 v[34:35], v[34:35], 1.0 op_sel_hi:[1,0]
    v_pk_add_f32 v[36:37], v[36:37], 1.0 op_sel_hi:[1,0]
    v_pk_add_f32 v[38:39], v[38:39], 1.0 op_sel_hi:[1,0]
    v_pk_add_f32 v[40:41], v[40:41], 1.0 op_sel_hi:[1,0]
    v_pk_add_f32 v[42:43], v[42:43], 1.0 op_sel_hi:[1,0]
    v_pk_add_f32 v[44:45], v[44:45], 1.0 op_sel_hi:[1,0]
    v_pk_add_f32 v[46:47], v[46:47], 1.0 op_sel_hi:[1,0]
    v_rcp_f32 v32, v32
    v_rcp_f32 v33, v33
    v_rcp_f32 v34, v34
    v_rcp_f32 v35, v35
    v_rcp_f32 v36, v36
    v_rcp_f32 v37, v37
    v_rcp_f32 v38, v38
    v_rcp_f32 v39, v39
    v_rcp_f32 v40, v40
    v_rcp_f32 v41, v41
    v_rcp_f32 v42, v42
    v_rcp_f32 v43, v43
    v_rcp_f32 v44, v44
    v_rcp_f32 v45, v45
    v_rcp_f32 v46, v46
    v_rcp_f32 v47, v47
    v_pk_mul_f32 v[176:177], v[176:177], v[32:33]
    v_pk_mul_f32 v[178:179], v[178:179], v[34:35]
    v_pk_mul_f32 v[180:181], v[180:181], v[36:37]
    v_pk_mul_f32 v[182:183], v[182:183], v[38:39]
    v_pk_mul_f32 v[184:185], v[184:185], v[40:41]
    v_pk_mul_f32 v[186:187], v[186:187], v[42:43]
    v_pk_mul_f32 v[188:189], v[188:189], v[44:45]
    v_pk_mul_f32 v[190:191], v[190:191], v[46:47]
    v_cvt_pk_bf16_f32 v176, v176, v177
    v_cvt_pk_bf16_f32 v177, v178, v179
    v_cvt_pk_bf16_f32 v178, v180, v181
    v_cvt_pk_bf16_f32 v179, v182, v183
    v_cvt_pk_bf16_f32 v180, v184, v185
    v_cvt_pk_bf16_f32 v181, v186, v187
    v_cvt_pk_bf16_f32 v182, v188, v189
    v_cvt_pk_bf16_f32 v183, v190, v191
    buffer_store_dwordx4 v[176:179], v1, s[12:15], s35 offen offset:0 sc1
    buffer_store_dwordx4 v[180:183], v1, s[12:15], s35 offen offset:1024 sc1
    s_waitcnt lgkmcnt(4)
    v_lshlrev_b32 v48, 16, v136
    v_and_b32 v49, v17, v136
    v_lshlrev_b32 v50, 16, v137
    v_and_b32 v51, v17, v137
    v_lshlrev_b32 v52, 16, v138
    v_and_b32 v53, v17, v138
    v_lshlrev_b32 v54, 16, v139
    v_and_b32 v55, v17, v139
    v_lshlrev_b32 v56, 16, v140
    v_and_b32 v57, v17, v140
    v_lshlrev_b32 v58, 16, v141
    v_and_b32 v59, v17, v141
    v_lshlrev_b32 v60, 16, v142
    v_and_b32 v61, v17, v142
    v_lshlrev_b32 v62, 16, v143
    v_and_b32 v63, v17, v143
    v_pk_fma_f32 v[32:33], v[80:81], v[24:25], v[48:49] op_sel:[0,1,0] op_sel_hi:[1,1,1]
    v_pk_fma_f32 v[34:35], v[82:83], v[24:25], v[50:51] op_sel:[0,1,0] op_sel_hi:[1,1,1]
    v_pk_fma_f32 v[36:37], v[84:85], v[24:25], v[52:53] op_sel:[0,1,0] op_sel_hi:[1,1,1]
    v_pk_fma_f32 v[38:39], v[86:87], v[24:25], v[54:55] op_sel:[0,1,0] op_sel_hi:[1,1,1]
    v_pk_fma_f32 v[40:41], v[88:89], v[24:25], v[56:57] op_sel:[0,1,0] op_sel_hi:[1,1,1]
    v_pk_fma_f32 v[42:43], v[90:91], v[24:25], v[58:59] op_sel:[0,1,0] op_sel_hi:[1,1,1]
    v_pk_fma_f32 v[44:45], v[92:93], v[24:25], v[60:61] op_sel:[0,1,0] op_sel_hi:[1,1,1]
    v_pk_fma_f32 v[46:47], v[94:95], v[24:25], v[62:63] op_sel:[0,1,0] op_sel_hi:[1,1,1]
    ds_read_b128 v[112:115], v15 offset:384
    ds_read_b128 v[116:119], v15 offset:400
    ds_read_b128 v[120:123], v15 offset:448
    ds_read_b128 v[124:127], v15 offset:464
    v_pk_fma_f32 v[192:193], v[192:193], v[24:25], v[32:33] op_sel_hi:[1,0,1]
    v_pk_fma_f32 v[194:195], v[194:195], v[24:25], v[34:35] op_sel_hi:[1,0,1]
    v_pk_fma_f32 v[196:197], v[196:197], v[24:25], v[36:37] op_sel_hi:[1,0,1]
    v_pk_fma_f32 v[198:199], v[198:199], v[24:25], v[38:39] op_sel_hi:[1,0,1]
    v_pk_fma_f32 v[200:201], v[200:201], v[24:25], v[40:41] op_sel_hi:[1,0,1]
    v_pk_fma_f32 v[202:203], v[202:203], v[24:25], v[42:43] op_sel_hi:[1,0,1]
    v_pk_fma_f32 v[204:205], v[204:205], v[24:25], v[44:45] op_sel_hi:[1,0,1]
    v_pk_fma_f32 v[206:207], v[206:207], v[24:25], v[46:47] op_sel_hi:[1,0,1]
    v_pk_mul_f32 v[32:33], v[192:193], v[192:193]
    v_pk_mul_f32 v[34:35], v[194:195], v[194:195]
    v_pk_mul_f32 v[36:37], v[196:197], v[196:197]
    v_pk_mul_f32 v[38:39], v[198:199], v[198:199]
    v_pk_mul_f32 v[40:41], v[200:201], v[200:201]
    v_pk_mul_f32 v[42:43], v[202:203], v[202:203]
    v_pk_mul_f32 v[44:45], v[204:205], v[204:205]
    v_pk_mul_f32 v[46:47], v[206:207], v[206:207]
    v_pk_fma_f32 v[32:33], v[32:33], v[12:13], v[12:13] op_sel:[0,1,0] op_sel_hi:[1,1,0]
    v_pk_fma_f32 v[34:35], v[34:35], v[12:13], v[12:13] op_sel:[0,1,0] op_sel_hi:[1,1,0]
    v_pk_fma_f32 v[36:37], v[36:37], v[12:13], v[12:13] op_sel:[0,1,0] op_sel_hi:[1,1,0]
    v_pk_fma_f32 v[38:39], v[38:39], v[12:13], v[12:13] op_sel:[0,1,0] op_sel_hi:[1,1,0]
    v_pk_fma_f32 v[40:41], v[40:41], v[12:13], v[12:13] op_sel:[0,1,0] op_sel_hi:[1,1,0]
    v_pk_fma_f32 v[42:43], v[42:43], v[12:13], v[12:13] op_sel:[0,1,0] op_sel_hi:[1,1,0]
    v_pk_fma_f32 v[44:45], v[44:45], v[12:13], v[12:13] op_sel:[0,1,0] op_sel_hi:[1,1,0]
    v_pk_fma_f32 v[46:47], v[46:47], v[12:13], v[12:13] op_sel:[0,1,0] op_sel_hi:[1,1,0]
    v_pk_mul_f32 v[32:33], v[32:33], v[192:193]
    v_pk_mul_f32 v[34:35], v[34:35], v[194:195]
    v_pk_mul_f32 v[36:37], v[36:37], v[196:197]
    v_pk_mul_f32 v[38:39], v[38:39], v[198:199]
    v_pk_mul_f32 v[40:41], v[40:41], v[200:201]
    v_pk_mul_f32 v[42:43], v[42:43], v[202:203]
    v_pk_mul_f32 v[44:45], v[44:45], v[204:205]
    v_pk_mul_f32 v[46:47], v[46:47], v[206:207]
    v_exp_f32 v32, v32
    v_exp_f32 v33, v33
    v_exp_f32 v34, v34
    v_exp_f32 v35, v35
    v_exp_f32 v36, v36
    v_exp_f32 v37, v37
    v_exp_f32 v38, v38
    v_exp_f32 v39, v39
    v_exp_f32 v40, v40
    v_exp_f32 v41, v41
    v_exp_f32 v42, v42
    v_exp_f32 v43, v43
    v_exp_f32 v44, v44
    v_exp_f32 v45, v45
    v_exp_f32 v46, v46
    v_exp_f32 v47, v47
    v_pk_add_f32 v[32:33], v[32:33], 1.0 op_sel_hi:[1,0]
    v_pk_add_f32 v[34:35], v[34:35], 1.0 op_sel_hi:[1,0]
    v_pk_add_f32 v[36:37], v[36:37], 1.0 op_sel_hi:[1,0]
    v_pk_add_f32 v[38:39], v[38:39], 1.0 op_sel_hi:[1,0]
    v_pk_add_f32 v[40:41], v[40:41], 1.0 op_sel_hi:[1,0]
    v_pk_add_f32 v[42:43], v[42:43], 1.0 op_sel_hi:[1,0]
    v_pk_add_f32 v[44:45], v[44:45], 1.0 op_sel_hi:[1,0]
    v_pk_add_f32 v[46:47], v[46:47], 1.0 op_sel_hi:[1,0]
    v_rcp_f32 v32, v32
    v_rcp_f32 v33, v33
    v_rcp_f32 v34, v34
    v_rcp_f32 v35, v35
    v_rcp_f32 v36, v36
    v_rcp_f32 v37, v37
    v_rcp_f32 v38, v38
    v_rcp_f32 v39, v39
    v_rcp_f32 v40, v40
    v_rcp_f32 v41, v41
    v_rcp_f32 v42, v42
    v_rcp_f32 v43, v43
    v_rcp_f32 v44, v44
    v_rcp_f32 v45, v45
    v_rcp_f32 v46, v46
    v_rcp_f32 v47, v47
    v_pk_mul_f32 v[192:193], v[192:193], v[32:33]
    v_pk_mul_f32 v[194:195], v[194:195], v[34:35]
    v_pk_mul_f32 v[196:197], v[196:197], v[36:37]
    v_pk_mul_f32 v[198:199], v[198:199], v[38:39]
    v_pk_mul_f32 v[200:201], v[200:201], v[40:41]
    v_pk_mul_f32 v[202:203], v[202:203], v[42:43]
    v_pk_mul_f32 v[204:205], v[204:205], v[44:45]
    v_pk_mul_f32 v[206:207], v[206:207], v[46:47]
    v_cvt_pk_bf16_f32 v192, v192, v193
    v_cvt_pk_bf16_f32 v193, v194, v195
    v_cvt_pk_bf16_f32 v194, v196, v197
    v_cvt_pk_bf16_f32 v195, v198, v199
    v_cvt_pk_bf16_f32 v196, v200, v201
    v_cvt_pk_bf16_f32 v197, v202, v203
    v_cvt_pk_bf16_f32 v198, v204, v205
    v_cvt_pk_bf16_f32 v199, v206, v207
    buffer_store_dwordx4 v[192:195], v1, s[12:15], s35 offen offset:2048 sc1
    buffer_store_dwordx4 v[196:199], v1, s[12:15], s35 offen offset:3072 sc1
    s_add_u32 s35, s35, 4096
    s_waitcnt lgkmcnt(4)
    v_lshlrev_b32 v48, 16, v144
    v_and_b32 v49, v17, v144
    v_lshlrev_b32 v50, 16, v145
    v_and_b32 v51, v17, v145
    v_lshlrev_b32 v52, 16, v146
    v_and_b32 v53, v17, v146
    v_lshlrev_b32 v54, 16, v147
    v_and_b32 v55, v17, v147
    v_lshlrev_b32 v56, 16, v148
    v_and_b32 v57, v17, v148
    v_lshlrev_b32 v58, 16, v149
    v_and_b32 v59, v17, v149
    v_lshlrev_b32 v60, 16, v150
    v_and_b32 v61, v17, v150
    v_lshlrev_b32 v62, 16, v151
    v_and_b32 v63, v17, v151
    v_pk_fma_f32 v[32:33], v[96:97], v[24:25], v[48:49] op_sel:[0,1,0] op_sel_hi:[1,1,1]
    v_pk_fma_f32 v[34:35], v[98:99], v[24:25], v[50:51] op_sel:[0,1,0] op_sel_hi:[1,1,1]
    v_pk_fma_f32 v[36:37], v[100:101], v[24:25], v[52:53] op_sel:[0,1,0] op_sel_hi:[1,1,1]
    v_pk_fma_f32 v[38:39], v[102:103], v[24:25], v[54:55] op_sel:[0,1,0] op_sel_hi:[1,1,1]
    v_pk_fma_f32 v[40:41], v[104:105], v[24:25], v[56:57] op_sel:[0,1,0] op_sel_hi:[1,1,1]
    v_pk_fma_f32 v[42:43], v[106:107], v[24:25], v[58:59] op_sel:[0,1,0] op_sel_hi:[1,1,1]
    v_pk_fma_f32 v[44:45], v[108:109], v[24:25], v[60:61] op_sel:[0,1,0] op_sel_hi:[1,1,1]
    v_pk_fma_f32 v[46:47], v[110:111], v[24:25], v[62:63] op_sel:[0,1,0] op_sel_hi:[1,1,1]
    v_pk_fma_f32 v[208:209], v[208:209], v[24:25], v[32:33] op_sel_hi:[1,0,1]
    v_pk_fma_f32 v[210:211], v[210:211], v[24:25], v[34:35] op_sel_hi:[1,0,1]
    v_pk_fma_f32 v[212:213], v[212:213], v[24:25], v[36:37] op_sel_hi:[1,0,1]
    v_pk_fma_f32 v[214:215], v[214:215], v[24:25], v[38:39] op_sel_hi:[1,0,1]
    v_pk_fma_f32 v[216:217], v[216:217], v[24:25], v[40:41] op_sel_hi:[1,0,1]
    v_pk_fma_f32 v[218:219], v[218:219], v[24:25], v[42:43] op_sel_hi:[1,0,1]
    v_pk_fma_f32 v[220:221], v[220:221], v[24:25], v[44:45] op_sel_hi:[1,0,1]
    v_pk_fma_f32 v[222:223], v[222:223], v[24:25], v[46:47] op_sel_hi:[1,0,1]
    v_pk_mul_f32 v[32:33], v[208:209], v[208:209]
    v_pk_mul_f32 v[34:35], v[210:211], v[210:211]
    v_pk_mul_f32 v[36:37], v[212:213], v[212:213]
    v_pk_mul_f32 v[38:39], v[214:215], v[214:215]
    v_pk_mul_f32 v[40:41], v[216:217], v[216:217]
    v_pk_mul_f32 v[42:43], v[218:219], v[218:219]
    v_pk_mul_f32 v[44:45], v[220:221], v[220:221]
    v_pk_mul_f32 v[46:47], v[222:223], v[222:223]
    v_pk_fma_f32 v[32:33], v[32:33], v[12:13], v[12:13] op_sel:[0,1,0] op_sel_hi:[1,1,0]
    v_pk_fma_f32 v[34:35], v[34:35], v[12:13], v[12:13] op_sel:[0,1,0] op_sel_hi:[1,1,0]
    v_pk_fma_f32 v[36:37], v[36:37], v[12:13], v[12:13] op_sel:[0,1,0] op_sel_hi:[1,1,0]
    v_pk_fma_f32 v[38:39], v[38:39], v[12:13], v[12:13] op_sel:[0,1,0] op_sel_hi:[1,1,0]
    v_pk_fma_f32 v[40:41], v[40:41], v[12:13], v[12:13] op_sel:[0,1,0] op_sel_hi:[1,1,0]
    v_pk_fma_f32 v[42:43], v[42:43], v[12:13], v[12:13] op_sel:[0,1,0] op_sel_hi:[1,1,0]
    v_pk_fma_f32 v[44:45], v[44:45], v[12:13], v[12:13] op_sel:[0,1,0] op_sel_hi:[1,1,0]
    v_pk_fma_f32 v[46:47], v[46:47], v[12:13], v[12:13] op_sel:[0,1,0] op_sel_hi:[1,1,0]
    v_pk_mul_f32 v[32:33], v[32:33], v[208:209]
    v_pk_mul_f32 v[34:35], v[34:35], v[210:211]
    v_pk_mul_f32 v[36:37], v[36:37], v[212:213]
    v_pk_mul_f32 v[38:39], v[38:39], v[214:215]
    v_pk_mul_f32 v[40:41], v[40:41], v[216:217]
    v_pk_mul_f32 v[42:43], v[42:43], v[218:219]
    v_pk_mul_f32 v[44:45], v[44:45], v[220:221]
    v_pk_mul_f32 v[46:47], v[46:47], v[222:223]
    v_exp_f32 v32, v32
    v_exp_f32 v33, v33
    v_exp_f32 v34, v34
    v_exp_f32 v35, v35
    v_exp_f32 v36, v36
    v_exp_f32 v37, v37
    v_exp_f32 v38, v38
    v_exp_f32 v39, v39
    v_exp_f32 v40, v40
    v_exp_f32 v41, v41
    v_exp_f32 v42, v42
    v_exp_f32 v43, v43
    v_exp_f32 v44, v44
    v_exp_f32 v45, v45
    v_exp_f32 v46, v46
    v_exp_f32 v47, v47
    v_pk_add_f32 v[32:33], v[32:33], 1.0 op_sel_hi:[1,0]
    v_pk_add_f32 v[34:35], v[34:35], 1.0 op_sel_hi:[1,0]
    v_pk_add_f32 v[36:37], v[36:37], 1.0 op_sel_hi:[1,0]
    v_pk_add_f32 v[38:39], v[38:39], 1.0 op_sel_hi:[1,0]
    v_pk_add_f32 v[40:41], v[40:41], 1.0 op_sel_hi:[1,0]
    v_pk_add_f32 v[42:43], v[42:43], 1.0 op_sel_hi:[1,0]
    v_pk_add_f32 v[44:45], v[44:45], 1.0 op_sel_hi:[1,0]
    v_pk_add_f32 v[46:47], v[46:47], 1.0 op_sel_hi:[1,0]
    v_rcp_f32 v32, v32
    v_rcp_f32 v33, v33
    v_rcp_f32 v34, v34
    v_rcp_f32 v35, v35
    v_rcp_f32 v36, v36
    v_rcp_f32 v37, v37
    v_rcp_f32 v38, v38
    v_rcp_f32 v39, v39
    v_rcp_f32 v40, v40
    v_rcp_f32 v41, v41
    v_rcp_f32 v42, v42
    v_rcp_f32 v43, v43
    v_rcp_f32 v44, v44
    v_rcp_f32 v45, v45
    v_rcp_f32 v46, v46
    v_rcp_f32 v47, v47
    v_pk_mul_f32 v[208:209], v[208:209], v[32:33]
    v_pk_mul_f32 v[210:211], v[210:211], v[34:35]
    v_pk_mul_f32 v[212:213], v[212:213], v[36:37]
    v_pk_mul_f32 v[214:215], v[214:215], v[38:39]
    v_pk_mul_f32 v[216:217], v[216:217], v[40:41]
    v_pk_mul_f32 v[218:219], v[218:219], v[42:43]
    v_pk_mul_f32 v[220:221], v[220:221], v[44:45]
    v_pk_mul_f32 v[222:223], v[222:223], v[46:47]
    v_cvt_pk_bf16_f32 v208, v208, v209
    v_cvt_pk_bf16_f32 v209, v210, v211
    v_cvt_pk_bf16_f32 v210, v212, v213
    v_cvt_pk_bf16_f32 v211, v214, v215
    v_cvt_pk_bf16_f32 v212, v216, v217
    v_cvt_pk_bf16_f32 v213, v218, v219
    v_cvt_pk_bf16_f32 v214, v220, v221
    v_cvt_pk_bf16_f32 v215, v222, v223
    buffer_store_dwordx4 v[208:211], v1, s[12:15], s35 offen offset:0 sc1
    buffer_store_dwordx4 v[212:215], v1, s[12:15], s35 offen offset:1024 sc1
    s_waitcnt lgkmcnt(0)
    v_lshlrev_b32 v48, 16, v152
    v_and_b32 v49, v17, v152
    v_lshlrev_b32 v50, 16, v153
    v_and_b32 v51, v17, v153
    v_lshlrev_b32 v52, 16, v154
    v_and_b32 v53, v17, v154
    v_lshlrev_b32 v54, 16, v155
    v_and_b32 v55, v17, v155
    v_lshlrev_b32 v56, 16, v156
    v_and_b32 v57, v17, v156
    v_lshlrev_b32 v58, 16, v157
    v_and_b32 v59, v17, v157
    v_lshlrev_b32 v60, 16, v158
    v_and_b32 v61, v17, v158
    v_lshlrev_b32 v62, 16, v159
    v_and_b32 v63, v17, v159
    v_pk_fma_f32 v[32:33], v[112:113], v[24:25], v[48:49] op_sel:[0,1,0] op_sel_hi:[1,1,1]
    v_pk_fma_f32 v[34:35], v[114:115], v[24:25], v[50:51] op_sel:[0,1,0] op_sel_hi:[1,1,1]
    v_pk_fma_f32 v[36:37], v[116:117], v[24:25], v[52:53] op_sel:[0,1,0] op_sel_hi:[1,1,1]
    v_pk_fma_f32 v[38:39], v[118:119], v[24:25], v[54:55] op_sel:[0,1,0] op_sel_hi:[1,1,1]
    v_pk_fma_f32 v[40:41], v[120:121], v[24:25], v[56:57] op_sel:[0,1,0] op_sel_hi:[1,1,1]
    v_pk_fma_f32 v[42:43], v[122:123], v[24:25], v[58:59] op_sel:[0,1,0] op_sel_hi:[1,1,1]
    v_pk_fma_f32 v[44:45], v[124:125], v[24:25], v[60:61] op_sel:[0,1,0] op_sel_hi:[1,1,1]
    v_pk_fma_f32 v[46:47], v[126:127], v[24:25], v[62:63] op_sel:[0,1,0] op_sel_hi:[1,1,1]
    v_pk_fma_f32 v[224:225], v[224:225], v[24:25], v[32:33] op_sel_hi:[1,0,1]
    v_pk_fma_f32 v[226:227], v[226:227], v[24:25], v[34:35] op_sel_hi:[1,0,1]
    v_pk_fma_f32 v[228:229], v[228:229], v[24:25], v[36:37] op_sel_hi:[1,0,1]
    v_pk_fma_f32 v[230:231], v[230:231], v[24:25], v[38:39] op_sel_hi:[1,0,1]
    v_pk_fma_f32 v[232:233], v[232:233], v[24:25], v[40:41] op_sel_hi:[1,0,1]
    v_pk_fma_f32 v[234:235], v[234:235], v[24:25], v[42:43] op_sel_hi:[1,0,1]
    v_pk_fma_f32 v[236:237], v[236:237], v[24:25], v[44:45] op_sel_hi:[1,0,1]
    v_pk_fma_f32 v[238:239], v[238:239], v[24:25], v[46:47] op_sel_hi:[1,0,1]
    v_pk_mul_f32 v[32:33], v[224:225], v[224:225]
    v_pk_mul_f32 v[34:35], v[226:227], v[226:227]
    v_pk_mul_f32 v[36:37], v[228:229], v[228:229]
    v_pk_mul_f32 v[38:39], v[230:231], v[230:231]
    v_pk_mul_f32 v[40:41], v[232:233], v[232:233]
    v_pk_mul_f32 v[42:43], v[234:235], v[234:235]
    v_pk_mul_f32 v[44:45], v[236:237], v[236:237]
    v_pk_mul_f32 v[46:47], v[238:239], v[238:239]
    v_pk_fma_f32 v[32:33], v[32:33], v[12:13], v[12:13] op_sel:[0,1,0] op_sel_hi:[1,1,0]
    v_pk_fma_f32 v[34:35], v[34:35], v[12:13], v[12:13] op_sel:[0,1,0] op_sel_hi:[1,1,0]
    v_pk_fma_f32 v[36:37], v[36:37], v[12:13], v[12:13] op_sel:[0,1,0] op_sel_hi:[1,1,0]
    v_pk_fma_f32 v[38:39], v[38:39], v[12:13], v[12:13] op_sel:[0,1,0] op_sel_hi:[1,1,0]
    v_pk_fma_f32 v[40:41], v[40:41], v[12:13], v[12:13] op_sel:[0,1,0] op_sel_hi:[1,1,0]
    v_pk_fma_f32 v[42:43], v[42:43], v[12:13], v[12:13] op_sel:[0,1,0] op_sel_hi:[1,1,0]
    v_pk_fma_f32 v[44:45], v[44:45], v[12:13], v[12:13] op_sel:[0,1,0] op_sel_hi:[1,1,0]
    v_pk_fma_f32 v[46:47], v[46:47], v[12:13], v[12:13] op_sel:[0,1,0] op_sel_hi:[1,1,0]
    v_pk_mul_f32 v[32:33], v[32:33], v[224:225]
    v_pk_mul_f32 v[34:35], v[34:35], v[226:227]
    v_pk_mul_f32 v[36:37], v[36:37], v[228:229]
    v_pk_mul_f32 v[38:39], v[38:39], v[230:231]
    v_pk_mul_f32 v[40:41], v[40:41], v[232:233]
    v_pk_mul_f32 v[42:43], v[42:43], v[234:235]
    v_pk_mul_f32 v[44:45], v[44:45], v[236:237]
    v_pk_mul_f32 v[46:47], v[46:47], v[238:239]
    v_exp_f32 v32, v32
    v_exp_f32 v33, v33
    v_exp_f32 v34, v34
    v_exp_f32 v35, v35
    v_exp_f32 v36, v36
    v_exp_f32 v37, v37
    v_exp_f32 v38, v38
    v_exp_f32 v39, v39
    v_exp_f32 v40, v40
    v_exp_f32 v41, v41
    v_exp_f32 v42, v42
    v_exp_f32 v43, v43
    v_exp_f32 v44, v44
    v_exp_f32 v45, v45
    v_exp_f32 v46, v46
    v_exp_f32 v47, v47
    v_pk_add_f32 v[32:33], v[32:33], 1.0 op_sel_hi:[1,0]
    v_pk_add_f32 v[34:35], v[34:35], 1.0 op_sel_hi:[1,0]
    v_pk_add_f32 v[36:37], v[36:37], 1.0 op_sel_hi:[1,0]
    v_pk_add_f32 v[38:39], v[38:39], 1.0 op_sel_hi:[1,0]
    v_pk_add_f32 v[40:41], v[40:41], 1.0 op_sel_hi:[1,0]
    v_pk_add_f32 v[42:43], v[42:43], 1.0 op_sel_hi:[1,0]
    v_pk_add_f32 v[44:45], v[44:45], 1.0 op_sel_hi:[1,0]
    v_pk_add_f32 v[46:47], v[46:47], 1.0 op_sel_hi:[1,0]
    v_rcp_f32 v32, v32
    v_rcp_f32 v33, v33
    v_rcp_f32 v34, v34
    v_rcp_f32 v35, v35
    v_rcp_f32 v36, v36
    v_rcp_f32 v37, v37
    v_rcp_f32 v38, v38
    v_rcp_f32 v39, v39
    v_rcp_f32 v40, v40
    v_rcp_f32 v41, v41
    v_rcp_f32 v42, v42
    v_rcp_f32 v43, v43
    v_rcp_f32 v44, v44
    v_rcp_f32 v45, v45
    v_rcp_f32 v46, v46
    v_rcp_f32 v47, v47
    v_pk_mul_f32 v[224:225], v[224:225], v[32:33]
    v_pk_mul_f32 v[226:227], v[226:227], v[34:35]
    v_pk_mul_f32 v[228:229], v[228:229], v[36:37]
    v_pk_mul_f32 v[230:231], v[230:231], v[38:39]
    v_pk_mul_f32 v[232:233], v[232:233], v[40:41]
    v_pk_mul_f32 v[234:235], v[234:235], v[42:43]
    v_pk_mul_f32 v[236:237], v[236:237], v[44:45]
    v_pk_mul_f32 v[238:239], v[238:239], v[46:47]
    v_cvt_pk_bf16_f32 v224, v224, v225
    v_cvt_pk_bf16_f32 v225, v226, v227
    v_cvt_pk_bf16_f32 v226, v228, v229
    v_cvt_pk_bf16_f32 v227, v230, v231
    v_cvt_pk_bf16_f32 v228, v232, v233
    v_cvt_pk_bf16_f32 v229, v234, v235
    v_cvt_pk_bf16_f32 v230, v236, v237
    v_cvt_pk_bf16_f32 v231, v238, v239
    buffer_store_dwordx4 v[224:227], v1, s[12:15], s35 offen offset:2048 sc1
    buffer_store_dwordx4 v[228:231], v1, s[12:15], s35 offen offset:3072 sc1
    s_waitcnt vmcnt(0)
    s_barrier
    s_cmp_lg_u32 s6, 0
    s_cbranch_scc1 m_ns4
    v_mov_b32 v28, 0
    v_mov_b32 v29, 1
    s_mov_b64 exec, 1
    buffer_atomic_add v29, v28, s[12:15], s58 offen
    s_mov_b64 exec, -1
m_ns4:
m_p5:
    v_mov_b32 v48, v240
    v_mov_b32 v49, v241
    v_mov_b32 v50, v242
    v_mov_b32 v51, v243
    v_mov_b32 v52, v244
    v_mov_b32 v53, v245
    v_mov_b32 v54, v246
    v_mov_b32 v55, v247
    s_lshl_b32 s9, s48, 1
    s_add_u32 s50, s9, s7
    s_xor_b32 s10, s50, 1
    s_mul_i32 s11, s6, 28
    s_mul_i32 s40, s50, 112
    s_add_u32 s40, s40, s11
    s_lshl_b32 s40, s40, 10
    s_add_u32 s40, s40, 0xa00000
    s_mul_i32 s41, s10, 112
    s_add_u32 s41, s41, s11
    s_lshl_b32 s41, s41, 10
    s_add_u32 s41, s41, 0xa00000
    s_lshl_b32 s9, s49, 1
    s_add_u32 s9, s9, s8
    s_xor_b32 s10, s9, 1
    s_mul_i32 s42, s9, 112
    s_add_u32 s42, s42, s11
    s_lshl_b32 s42, s42, 10
    s_add_u32 s42, s42, 0x1400000
    s_mul_i32 s43, s10, 112
    s_add_u32 s43, s43, s11
    s_lshl_b32 s43, s43, 10
    s_add_u32 s43, s43, 0x1400000
    s_lshl_b32 s51, s9, 1
    v_lshlrev_b32 v6, 10, v4
    v_lshl_add_u32 v6, v5, 4, v6
    s_mov_b32 s32, s64
    s_mov_b32 s33, s65
    s_mov_b32 s34, 0x400
    s_mov_b32 s35, 0x00020000
    s_mov_b32 s36, s66
    s_mov_b32 s37, s67
    s_mov_b32 s38, 0x200000
    s_mov_b32 s39, 0x00020000
    v_lshlrev_b32 v7, 4, v5
    s_lshl_b32 s9, s51, 5
    buffer_load_dwordx4 v[40:43], v7, s[32:35], s9 offen
    buffer_load_dwordx4 v[44:47], v7, s[32:35], s9 offen offset:32
    buffer_load_dwordx4 v[72:75], v1, s[12:15], s42 offen offset:0 sc1
    buffer_load_dwordx4 v[76:79], v1, s[12:15], s43 offen offset:0 sc1
    buffer_load_dwordx4 v[88:91], v1, s[12:15], s42 offen offset:1024 sc1
    buffer_load_dwordx4 v[92:95], v1, s[12:15], s43 offen offset:1024 sc1
    buffer_load_dwordx4 v[104:107], v1, s[12:15], s42 offen offset:2048 sc1
    buffer_load_dwordx4 v[108:111], v1, s[12:15], s43 offen offset:2048 sc1
    buffer_load_dwordx4 v[120:123], v1, s[12:15], s42 offen offset:3072 sc1
    buffer_load_dwordx4 v[124:127], v1, s[12:15], s43 offen offset:3072 sc1
    s_add_u32 s42, s42, 4096
    s_add_u32 s43, s43, 4096
    buffer_load_dwordx4 v[136:139], v1, s[12:15], s42 offen offset:0 sc1
    buffer_load_dwordx4 v[140:143], v1, s[12:15], s43 offen offset:0 sc1
    buffer_load_dwordx4 v[152:155], v1, s[12:15], s42 offen offset:1024 sc1
    buffer_load_dwordx4 v[156:159], v1, s[12:15], s43 offen offset:1024 sc1
    buffer_load_dwordx4 v[168:171], v1, s[12:15], s42 offen offset:2048 sc1
    buffer_load_dwordx4 v[172:175], v1, s[12:15], s43 offen offset:2048 sc1
    s_add_u32 s42, s42, 3072
    s_add_u32 s43, s43, 3072
    s_cmp_lg_u32 s6, 0
    s_cbranch_scc1 m_np5
    v_mov_b32 v28, 0
    s_mov_b32 s55, 0
m_sp4:
    buffer_load_dword v29, v28, s[12:15], s59 offen sc1
    s_waitcnt vmcnt(0)
    v_readfirstlane_b32 s54, v29
    s_cmp_ge_u32 s54, 14
    s_cbranch_scc1 m_sp4d
    s_add_u32 s55, s55, 1
    s_cmp_gt_u32 s55, 200000
    s_cbranch_scc1 m_sp4d
    s_sleep 4
    s_branch m_sp4
m_sp4d:
m_np5:
    s_barrier
    buffer_load_dwordx4 v[64:67], v1, s[12:15], s40 offen offset:0 sc1
    buffer_load_dwordx4 v[68:71], v1, s[12:15], s41 offen offset:0 sc1
    buffer_load_dwordx4 v[80:83], v1, s[12:15], s40 offen offset:1024 sc1
    buffer_load_dwordx4 v[84:87], v1, s[12:15], s41 offen offset:1024 sc1
    buffer_load_dwordx4 v[96:99], v1, s[12:15], s40 offen offset:2048 sc1
    buffer_load_dwordx4 v[100:103], v1, s[12:15], s41 offen offset:2048 sc1
    buffer_load_dwordx4 v[112:115], v1, s[12:15], s40 offen offset:3072 sc1
    buffer_load_dwordx4 v[116:119], v1, s[12:15], s41 offen offset:3072 sc1
    s_add_u32 s40, s40, 4096
    s_add_u32 s41, s41, 4096
    buffer_load_dwordx4 v[128:131], v1, s[12:15], s40 offen offset:0 sc1
    buffer_load_dwordx4 v[132:135], v1, s[12:15], s41 offen offset:0 sc1
    buffer_load_dwordx4 v[144:147], v1, s[12:15], s40 offen offset:1024 sc1
    buffer_load_dwordx4 v[148:151], v1, s[12:15], s41 offen offset:1024 sc1
    buffer_load_dwordx4 v[160:163], v1, s[12:15], s40 offen offset:2048 sc1
    buffer_load_dwordx4 v[164:167], v1, s[12:15], s41 offen offset:2048 sc1
    s_add_u32 s40, s40, 3072
    s_add_u32 s41, s41, 3072
    s_waitcnt vmcnt(12)
    v_mfma_f32_32x32x16_bf16 v[192:207], v[72:75], v[64:67], 0
    v_mfma_f32_32x32x16_bf16 v[208:223], v[72:75], v[68:71], 0
    v_mfma_f32_32x32x16_bf16 v[224:239], v[76:79], v[64:67], 0
    v_mfma_f32_32x32x16_bf16 v[240:255], v[76:79], v[68:71], 0
    buffer_load_dwordx4 v[64:67], v1, s[12:15], s40 offen offset:0 sc1
    buffer_load_dwordx4 v[72:75], v1, s[12:15], s42 offen offset:0 sc1
    buffer_load_dwordx4 v[68:71], v1, s[12:15], s41 offen offset:0 sc1
    buffer_load_dwordx4 v[76:79], v1, s[12:15], s43 offen offset:0 sc1
    s_waitcnt vmcnt(14)
    v_mfma_f32_32x32x16_bf16 v[192:207], v[88:91], v[80:83], v[192:207]
    v_mfma_f32_32x32x16_bf16 v[208:223], v[88:91], v[84:87], v[208:223]
    v_mfma_f32_32x32x16_bf16 v[224:239], v[92:95], v[80:83], v[224:239]
    v_mfma_f32_32x32x16_bf16 v[240:255], v[92:95], v[84:87], v[240:255]
    buffer_load_dwordx4 v[80:83], v1, s[12:15], s40 offen offset:1024 sc1
    buffer_load_dwordx4 v[88:91], v1, s[12:15], s42 offen offset:1024 sc1
    buffer_load_dwordx4 v[84:87], v1, s[12:15], s41 offen offset:1024 sc1
    buffer_load_dwordx4 v[92:95], v1, s[12:15], s43 offen offset:1024 sc1
    s_waitcnt vmcnt(16)
    v_mfma_f32_32x32x16_bf16 v[192:207], v[104:107], v[96:99], v[192:207]
    v_mfma_f32_32x32x16_bf16 v[208:223], v[104:107], v[100:103], v[208:223]
    v_mfma_f32_32x32x16_bf16 v[224:239], v[108:111], v[96:99], v[224:239]
    v_mfma_f32_32x32x16_bf16 v[240:255], v[108:111], v[100:103], v[240:255]
    buffer_load_dwordx4 v[96:99], v1, s[12:15], s40 offen offset:2048 sc1
    buffer_load_dwordx4 v[104:107], v1, s[12:15], s42 offen offset:2048 sc1
    buffer_load_dwordx4 v[100:103], v1, s[12:15], s41 offen offset:2048 sc1
    buffer_load_dwordx4 v[108:111], v1, s[12:15], s43 offen offset:2048 sc1
    s_waitcnt vmcnt(18)
    v_mfma_f32_32x32x16_bf16 v[192:207], v[120:123], v[112:115], v[192:207]
    v_mfma_f32_32x32x16_bf16 v[208:223], v[120:123], v[116:119], v[208:223]
    v_mfma_f32_32x32x16_bf16 v[224:239], v[124:127], v[112:115], v[224:239]
    v_mfma_f32_32x32x16_bf16 v[240:255], v[124:127], v[116:119], v[240:255]
    buffer_load_dwordx4 v[112:115], v1, s[12:15], s40 offen offset:3072 sc1
    buffer_load_dwordx4 v[120:123], v1, s[12:15], s42 offen offset:3072 sc1
    buffer_load_dwordx4 v[116:119], v1, s[12:15], s41 offen offset:3072 sc1
    buffer_load_dwordx4 v[124:127], v1, s[12:15], s43 offen offset:3072 sc1
    s_add_u32 s40, s40, 4096
    s_add_u32 s41, s41, 4096
    s_add_u32 s42, s42, 4096
    s_add_u32 s43, s43, 4096
    s_waitcnt vmcnt(20)
    v_mfma_f32_32x32x16_bf16 v[192:207], v[136:139], v[128:131], v[192:207]
    v_mfma_f32_32x32x16_bf16 v[208:223], v[136:139], v[132:135], v[208:223]
    v_mfma_f32_32x32x16_bf16 v[224:239], v[140:143], v[128:131], v[224:239]
    v_mfma_f32_32x32x16_bf16 v[240:255], v[140:143], v[132:135], v[240:255]
    buffer_load_dwordx4 v[128:131], v1, s[12:15], s40 offen offset:0 sc1
    buffer_load_dwordx4 v[136:139], v1, s[12:15], s42 offen offset:0 sc1
    buffer_load_dwordx4 v[132:135], v1, s[12:15], s41 offen offset:0 sc1
    buffer_load_dwordx4 v[140:143], v1, s[12:15], s43 offen offset:0 sc1
    s_waitcnt vmcnt(22)
    v_mfma_f32_32x32x16_bf16 v[192:207], v[152:155], v[144:147], v[192:207]
    v_mfma_f32_32x32x16_bf16 v[208:223], v[152:155], v[148:151], v[208:223]
    v_mfma_f32_32x32x16_bf16 v[224:239], v[156:159], v[144:147], v[224:239]
    v_mfma_f32_32x32x16_bf16 v[240:255], v[156:159], v[148:151], v[240:255]
    buffer_load_dwordx4 v[144:147], v1, s[12:15], s40 offen offset:1024 sc1
    buffer_load_dwordx4 v[152:155], v1, s[12:15], s42 offen offset:1024 sc1
    buffer_load_dwordx4 v[148:151], v1, s[12:15], s41 offen offset:1024 sc1
    buffer_load_dwordx4 v[156:159], v1, s[12:15], s43 offen offset:1024 sc1
    s_waitcnt vmcnt(24)
    v_mfma_f32_32x32x16_bf16 v[192:207], v[168:171], v[160:163], v[192:207]
    v_mfma_f32_32x32x16_bf16 v[208:223], v[168:171], v[164:167], v[208:223]
    v_mfma_f32_32x32x16_bf16 v[224:239], v[172:175], v[160:163], v[224:239]
    v_mfma_f32_32x32x16_bf16 v[240:255], v[172:175], v[164:167], v[240:255]
    buffer_load_dwordx4 v[160:163], v1, s[12:15], s40 offen offset:2048 sc1
    buffer_load_dwordx4 v[168:171], v1, s[12:15], s42 offen offset:2048 sc1
    buffer_load_dwordx4 v[164:167], v1, s[12:15], s41 offen offset:2048 sc1
    buffer_load_dwordx4 v[172:175], v1, s[12:15], s43 offen offset:2048 sc1
    s_add_u32 s40, s40, 3072
    s_add_u32 s41, s41, 3072
    s_add_u32 s42, s42, 3072
    s_add_u32 s43, s43, 3072
    s_mov_b32 s20, 0
m_kloop:
    s_waitcnt vmcnt(24)
    v_mfma_f32_32x32x16_bf16 v[192:207], v[72:75], v[64:67], v[192:207]
    v_mfma_f32_32x32x16_bf16 v[208:223], v[72:75], v[68:71], v[208:223]
    v_mfma_f32_32x32x16_bf16 v[224:239], v[76:79], v[64:67], v[224:239]
    v_mfma_f32_32x32x16_bf16 v[240:255], v[76:79], v[68:71], v[240:255]
    buffer_load_dwordx4 v[64:67], v1, s[12:15], s40 offen offset:0 sc1
    buffer_load_dwordx4 v[72:75], v1, s[12:15], s42 offen offset:0 sc1
    buffer_load_dwordx4 v[68:71], v1, s[12:15], s41 offen offset:0 sc1
    buffer_load_dwordx4 v[76:79], v1, s[12:15], s43 offen offset:0 sc1
    s_waitcnt vmcnt(24)
    v_mfma_f32_32x32x16_bf16 v[192:207], v[88:91], v[80:83], v[192:207]
    v_mfma_f32_32x32x16_bf16 v[208:223], v[88:91], v[84:87], v[208:223]
    v_mfma_f32_32x32x16_bf16 v[224:239], v[92:95], v[80:83], v[224:239]
    v_mfma_f32_32x32x16_bf16 v[240:255], v[92:95], v[84:87], v[240:255]
    buffer_load_dwordx4 v[80:83], v1, s[12:15], s40 offen offset:1024 sc1
    buffer_load_dwordx4 v[88:91], v1, s[12:15], s42 offen offset:1024 sc1
    buffer_load_dwordx4 v[84:87], v1, s[12:15], s41 offen offset:1024 sc1
    buffer_load_dwordx4 v[92:95], v1, s[12:15], s43 offen offset:1024 sc1
    s_waitcnt vmcnt(24)
    v_mfma_f32_32x32x16_bf16 v[192:207], v[104:107], v[96:99], v[192:207]
    v_mfma_f32_32x32x16_bf16 v[208:223], v[104:107], v[100:103], v[208:223]
    v_mfma_f32_32x32x16_bf16 v[224:239], v[108:111], v[96:99], v[224:239]
    v_mfma_f32_32x32x16_bf16 v[240:255], v[108:111], v[100:103], v[240:255]
    buffer_load_dwordx4 v[96:99], v1, s[12:15], s40 offen offset:2048 sc1
    buffer_load_dwordx4 v[104:107], v1, s[12:15], s42 offen offset:2048 sc1
    buffer_load_dwordx4 v[100:103], v1, s[12:15], s41 offen offset:2048 sc1
    buffer_load_dwordx4 v[108:111], v1, s[12:15], s43 offen offset:2048 sc1
    s_waitcnt vmcnt(24)
    v_mfma_f32_32x32x16_bf16 v[192:207], v[120:123], v[112:115], v[192:207]
    v_mfma_f32_32x32x16_bf16 v[208:223], v[120:123], v[116:119], v[208:223]
    v_mfma_f32_32x32x16_bf16 v[224:239], v[124:127], v[112:115], v[224:239]
    v_mfma_f32_32x32x16_bf16 v[240:255], v[124:127], v[116:119], v[240:255]
    buffer_load_dwordx4 v[112:115], v1, s[12:15], s40 offen offset:3072 sc1
    buffer_load_dwordx4 v[120:123], v1, s[12:15], s42 offen offset:3072 sc1
    buffer_load_dwordx4 v[116:119], v1, s[12:15], s41 offen offset:3072 sc1
    buffer_load_dwordx4 v[124:127], v1, s[12:15], s43 offen offset:3072 sc1
    s_add_u32 s40, s40, 4096
    s_add_u32 s41, s41, 4096
    s_add_u32 s42, s42, 4096
    s_add_u32 s43, s43, 4096
    s_waitcnt vmcnt(24)
    v_mfma_f32_32x32x16_bf16 v[192:207], v[136:139], v[128:131], v[192:207]
    v_mfma_f32_32x32x16_bf16 v[208:223], v[136:139], v[132:135], v[208:223]
    v_mfma_f32_32x32x16_bf16 v[224:239], v[140:143], v[128:131], v[224:239]
    v_mfma_f32_32x32x16_bf16 v[240:255], v[140:143], v[132:135], v[240:255]
    buffer_load_dwordx4 v[128:131], v1, s[12:15], s40 offen offset:0 sc1
    buffer_load_dwordx4 v[136:139], v1, s[12:15], s42 offen offset:0 sc1
    buffer_load_dwordx4 v[132:135], v1, s[12:15], s41 offen offset:0 sc1
    buffer_load_dwordx4 v[140:143], v1, s[12:15], s43 offen offset:0 sc1
    s_waitcnt vmcnt(24)
    v_mfma_f32_32x32x16_bf16 v[192:207], v[152:155], v[144:147], v[192:207]
    v_mfma_f32_32x32x16_bf16 v[208:223], v[152:155], v[148:151], v[208:223]
    v_mfma_f32_32x32x16_bf16 v[224:239], v[156:159], v[144:147], v[224:239]
    v_mfma_f32_32x32x16_bf16 v[240:255], v[156:159], v[148:151], v[240:255]
    buffer_load_dwordx4 v[144:147], v1, s[12:15], s40 offen offset:1024 sc1
    buffer_load_dwordx4 v[152:155], v1, s[12:15], s42 offen offset:1024 sc1
    buffer_load_dwordx4 v[148:151], v1, s[12:15], s41 offen offset:1024 sc1
    buffer_load_dwordx4 v[156:159], v1, s[12:15], s43 offen offset:1024 sc1
    s_waitcnt vmcnt(24)
    v_mfma_f32_32x32x16_bf16 v[192:207], v[168:171], v[160:163], v[192:207]
    v_mfma_f32_32x32x16_bf16 v[208:223], v[168:171], v[164:167], v[208:223]
    v_mfma_f32_32x32x16_bf16 v[224:239], v[172:175], v[160:163], v[224:239]
    v_mfma_f32_32x32x16_bf16 v[240:255], v[172:175], v[164:167], v[240:255]
    buffer_load_dwordx4 v[160:163], v1, s[12:15], s40 offen offset:2048 sc1
    buffer_load_dwordx4 v[168:171], v1, s[12:15], s42 offen offset:2048 sc1
    buffer_load_dwordx4 v[164:167], v1, s[12:15], s41 offen offset:2048 sc1
    buffer_load_dwordx4 v[172:175], v1, s[12:15], s43 offen offset:2048 sc1
    s_add_u32 s40, s40, 3072
    s_add_u32 s41, s41, 3072
    s_add_u32 s42, s42, 3072
    s_add_u32 s43, s43, 3072
    s_add_u32 s20, s20, 1
    s_cmp_lt_u32 s20, 2
    s_cbranch_scc1 m_kloop
    s_waitcnt vmcnt(24)
    v_mfma_f32_32x32x16_bf16 v[192:207], v[72:75], v[64:67], v[192:207]
    v_mfma_f32_32x32x16_bf16 v[208:223], v[72:75], v[68:71], v[208:223]
    v_mfma_f32_32x32x16_bf16 v[224:239], v[76:79], v[64:67], v[224:239]
    v_mfma_f32_32x32x16_bf16 v[240:255], v[76:79], v[68:71], v[240:255]
    s_waitcnt vmcnt(20)
    v_mfma_f32_32x32x16_bf16 v[192:207], v[88:91], v[80:83], v[192:207]
    v_mfma_f32_32x32x16_bf16 v[208:223], v[88:91], v[84:87], v[208:223]
    v_mfma_f32_32x32x16_bf16 v[224:239], v[92:95], v[80:83], v[224:239]
    v_mfma_f32_32x32x16_bf16 v[240:255], v[92:95], v[84:87], v[240:255]
    s_waitcnt vmcnt(16)
    v_mfma_f32_32x32x16_bf16 v[192:207], v[104:107], v[96:99], v[192:207]
    v_mfma_f32_32x32x16_bf16 v[208:223], v[104:107], v[100:103], v[208:223]
    v_mfma_f32_32x32x16_bf16 v[224:239], v[108:111], v[96:99], v[224:239]
    v_mfma_f32_32x32x16_bf16 v[240:255], v[108:111], v[100:103], v[240:255]
    s_waitcnt vmcnt(12)
    v_mfma_f32_32x32x16_bf16 v[192:207], v[120:123], v[112:115], v[192:207]
    v_mfma_f32_32x32x16_bf16 v[208:223], v[120:123], v[116:119], v[208:223]
    v_mfma_f32_32x32x16_bf16 v[224:239], v[124:127], v[112:115], v[224:239]
    v_mfma_f32_32x32x16_bf16 v[240:255], v[124:127], v[116:119], v[240:255]
    s_waitcnt vmcnt(8)
    v_mfma_f32_32x32x16_bf16 v[192:207], v[136:139], v[128:131], v[192:207]
    v_mfma_f32_32x32x16_bf16 v[208:223], v[136:139], v[132:135], v[208:223]
    v_mfma_f32_32x32x16_bf16 v[224:239], v[140:143], v[128:131], v[224:239]
    v_mfma_f32_32x32x16_bf16 v[240:255], v[140:143], v[132:135], v[240:255]
    s_waitcnt vmcnt(4)
    v_mfma_f32_32x32x16_bf16 v[192:207], v[152:155], v[144:147], v[192:207]
    v_mfma_f32_32x32x16_bf16 v[208:223], v[152:155], v[148:151], v[208:223]
    v_mfma_f32_32x32x16_bf16 v[224:239], v[156:159], v[144:147], v[224:239]
    v_mfma_f32_32x32x16_bf16 v[240:255], v[156:159], v[148:151], v[240:255]
    s_waitcnt vmcnt(0)
    v_mfma_f32_32x32x16_bf16 v[192:207], v[168:171], v[160:163], v[192:207]
    v_mfma_f32_32x32x16_bf16 v[208:223], v[168:171], v[164:167], v[208:223]
    v_mfma_f32_32x32x16_bf16 v[224:239], v[172:175], v[160:163], v[224:239]
    v_mfma_f32_32x32x16_bf16 v[240:255], v[172:175], v[164:167], v[240:255]
    s_nop 7
    s_xor_b32 s9, s6, 1
    s_mul_i32 s9, s9, 3
    s_add_u32 s9, s9, 0
    s_lshl_b32 s9, s9, 12
    v_add_u32 v9, s9, v1
    s_xor_b32 s9, s6, 2
    s_mul_i32 s9, s9, 3
    s_add_u32 s9, s9, 1
    s_lshl_b32 s9, s9, 12
    v_add_u32 v10, s9, v1
    s_xor_b32 s9, s6, 3
    s_mul_i32 s9, s9, 3
    s_add_u32 s9, s9, 2
    s_lshl_b32 s9, s9, 12
    v_add_u32 v11, s9, v1
    ds_write_b128 v9, v[224:227] offset:0
    ds_write_b128 v9, v[228:231] offset:1024
    ds_write_b128 v9, v[232:235] offset:2048
    ds_write_b128 v9, v[236:239] offset:3072
    ds_write_b128 v10, v[208:211] offset:0
    ds_write_b128 v10, v[212:215] offset:1024
    ds_write_b128 v10, v[216:219] offset:2048
    ds_write_b128 v10, v[220:223] offset:3072
    ds_write_b128 v11, v[240:243] offset:0
    ds_write_b128 v11, v[244:247] offset:1024
    ds_write_b128 v11, v[248:251] offset:2048
    ds_write_b128 v11, v[252:255] offset:3072
    s_mul_i32 s9, s6, 12288
    v_add_u32 v8, s9, v1
    v_lshlrev_b32 v112, 16, v48
    v_and_b32 v113, 0xffff0000, v48
    v_lshlrev_b32 v114, 16, v49
    v_and_b32 v115, 0xffff0000, v49
    v_lshlrev_b32 v116, 16, v50
    v_and_b32 v117, 0xffff0000, v50
    v_lshlrev_b32 v118, 16, v51
    v_and_b32 v119, 0xffff0000, v51
    v_lshlrev_b32 v120, 16, v52
    v_and_b32 v121, 0xffff0000, v52
    v_lshlrev_b32 v122, 16, v53
    v_and_b32 v123, 0xffff0000, v53
    v_lshlrev_b32 v124, 16, v54
    v_and_b32 v125, 0xffff0000, v54
    v_lshlrev_b32 v126, 16, v55
    v_and_b32 v127, 0xffff0000, v55
    v_lshlrev_b32 v128, 16, v40
    v_and_b32 v129, 0xffff0000, v40
    v_lshlrev_b32 v130, 16, v41
    v_and_b32 v131, 0xffff0000, v41
    v_lshlrev_b32 v132, 16, v42
    v_and_b32 v133, 0xffff0000, v42
    v_lshlrev_b32 v134, 16, v43
    v_and_b32 v135, 0xffff0000, v43
    v_lshlrev_b32 v136, 16, v44
    v_and_b32 v137, 0xffff0000, v44
    v_lshlrev_b32 v138, 16, v45
    v_and_b32 v139, 0xffff0000, v45
    v_lshlrev_b32 v140, 16, v46
    v_and_b32 v141, 0xffff0000, v46
    v_lshlrev_b32 v142, 16, v47
    v_and_b32 v143, 0xffff0000, v47
    v_pk_add_f32 v[112:113], v[112:113], v[128:129]
    v_pk_add_f32 v[114:115], v[114:115], v[130:131]
    v_pk_add_f32 v[116:117], v[116:117], v[132:133]
    v_pk_add_f32 v[118:119], v[118:119], v[134:135]
    v_pk_add_f32 v[120:121], v[120:121], v[136:137]
    v_pk_add_f32 v[122:123], v[122:123], v[138:139]
    v_pk_add_f32 v[124:125], v[124:125], v[140:141]
    v_pk_add_f32 v[126:127], v[126:127], v[142:143]
    v_pk_add_f32 v[192:193], v[192:193], v[112:113]
    v_pk_add_f32 v[194:195], v[194:195], v[114:115]
    v_pk_add_f32 v[196:197], v[196:197], v[116:117]
    v_pk_add_f32 v[198:199], v[198:199], v[118:119]
    v_pk_add_f32 v[200:201], v[200:201], v[120:121]
    v_pk_add_f32 v[202:203], v[202:203], v[122:123]
    v_pk_add_f32 v[204:205], v[204:205], v[124:125]
    v_pk_add_f32 v[206:207], v[206:207], v[126:127]
    s_waitcnt lgkmcnt(0)
    s_barrier
    ds_read_b128 v[64:67], v8 offset:0
    ds_read_b128 v[68:71], v8 offset:1024
    ds_read_b128 v[72:75], v8 offset:2048
    ds_read_b128 v[76:79], v8 offset:3072
    ds_read_b128 v[80:83], v8 offset:4096
    ds_read_b128 v[84:87], v8 offset:5120
    ds_read_b128 v[88:91], v8 offset:6144
    ds_read_b128 v[92:95], v8 offset:7168
    ds_read_b128 v[96:99], v8 offset:8192
    ds_read_b128 v[100:103], v8 offset:9216
    ds_read_b128 v[104:107], v8 offset:10240
    ds_read_b128 v[108:111], v8 offset:11264
    s_waitcnt lgkmcnt(8)
    v_pk_add_f32 v[192:193], v[192:193], v[64:65]
    v_pk_add_f32 v[194:195], v[194:195], v[66:67]
    v_pk_add_f32 v[196:197], v[196:197], v[68:69]
    v_pk_add_f32 v[198:199], v[198:199], v[70:71]
    v_pk_add_f32 v[200:201], v[200:201], v[72:73]
    v_pk_add_f32 v[202:203], v[202:203], v[74:75]
    v_pk_add_f32 v[204:205], v[204:205], v[76:77]
    v_pk_add_f32 v[206:207], v[206:207], v[78:79]
    s_waitcnt lgkmcnt(4)
    v_pk_add_f32 v[192:193], v[192:193], v[80:81]
    v_pk_add_f32 v[194:195], v[194:195], v[82:83]
    v_pk_add_f32 v[196:197], v[196:197], v[84:85]
    v_pk_add_f32 v[198:199], v[198:199], v[86:87]
    v_pk_add_f32 v[200:201], v[200:201], v[88:89]
    v_pk_add_f32 v[202:203], v[202:203], v[90:91]
    v_pk_add_f32 v[204:205], v[204:205], v[92:93]
    v_pk_add_f32 v[206:207], v[206:207], v[94:95]
    s_waitcnt lgkmcnt(0)
    v_pk_add_f32 v[192:193], v[192:193], v[96:97]
    v_pk_add_f32 v[194:195], v[194:195], v[98:99]
    v_pk_add_f32 v[196:197], v[196:197], v[100:101]
    v_pk_add_f32 v[198:199], v[198:199], v[102:103]
    v_pk_add_f32 v[200:201], v[200:201], v[104:105]
    v_pk_add_f32 v[202:203], v[202:203], v[106:107]
    v_pk_add_f32 v[204:205], v[204:205], v[108:109]
    v_pk_add_f32 v[206:207], v[206:207], v[110:111]
    v_cvt_pk_bf16_f32 v144, v192, v193
    v_cvt_pk_bf16_f32 v145, v194, v195
    v_cvt_pk_bf16_f32 v146, v196, v197
    v_cvt_pk_bf16_f32 v147, v198, v199
    v_cvt_pk_bf16_f32 v148, v200, v201
    v_cvt_pk_bf16_f32 v149, v202, v203
    v_cvt_pk_bf16_f32 v150, v204, v205
    v_cvt_pk_bf16_f32 v151, v206, v207
    buffer_store_dwordx4 v[144:147], v6, s[36:39], s52 offen
    buffer_store_dwordx4 v[148:151], v6, s[36:39], s52 offen offset:32
    s_endpgm
m_end:
    s_endpgm
mlp_code_end:
.section .rodata,"a"
.p2align 6
.amdhsa_kernel mlp_kernel
  .amdhsa_next_free_vgpr 256
  .amdhsa_next_free_sgpr 72
  .amdhsa_accum_offset 256
  .amdhsa_group_segment_fixed_size 0
  .amdhsa_kernarg_size 88
  .amdhsa_user_sgpr_count 2
  .amdhsa_user_sgpr_kernarg_segment_ptr 1
  .amdhsa_system_sgpr_workgroup_id_x 1
.end_amdhsa_kernel
.text
```
